```python
import torch

def _softmax(x, axis=-1):
    return torch.softmax(x, dim=axis)
def _gelu(x):
    return torch.nn.functional.gelu(x, approximate="tanh")
def _silu(x):
    return torch.nn.functional.silu(x)
def _sigmoid(x):
    return torch.sigmoid(x)
def _layernorm(x, axis=-1, eps=1e-5):
    m = x.mean(dim=axis, keepdim=True)
    v = x.var(dim=axis, keepdim=True, unbiased=False)
    return (x - m) / torch.sqrt(v + eps)
def _scatter_add(tgt, idx, src, axis=0):
    return tgt.clone().index_add_(axis, idx, src)
def _segment_sum(src, seg, n):
    out = torch.zeros((n,) + src.shape[1:], dtype=src.dtype)
    return out.index_add_(0, seg, src)
def _pad(x, pw):
    flat = tuple(v for pair in reversed(pw) for v in pair)
    return torch.nn.functional.pad(x, flat)

kernel_name = 'standalone__channel_attn_se__vision'

def setup_inputs():

    _w = (lambda a: (lambda t: t.to(torch.bfloat16) if t.is_floating_point() else t)(torch.as_tensor(a)))
    H = W = 512
    C = 192
    r = max(C // 16, 4)
    return {
        "x": _w((lambda *s: torch.randn(*s, dtype=torch.bfloat16) * 3.2)(1, H, W, C)),
        "w_down": _w((lambda *s: torch.randn(*s, dtype=torch.bfloat16) * 3.2)(C, r)),
        "w_up": _w((lambda *s: torch.randn(*s, dtype=torch.bfloat16) * 3.2)(r, C)),
    }

def reference(x, w_down, w_up):
    s = x.mean(axis=(1, 2))
    h = _silu(torch.einsum('bc,cr->br', s, w_down))
    g = _sigmoid(torch.einsum('br,rc->bc', h, w_up))
    return x * g[:, None, None, :]
```

```asm
; @launch grid=(256,1,1) block=(512,1,1) lds=77824
.amdgcn_target "amdgcn-amd-amdhsa--gfx950"
.text
.globl standalone__channel_attn_se__vision_kernel
.p2align 8
.type standalone__channel_attn_se__vision_kernel,@function
standalone__channel_attn_se__vision_kernel:
    s_load_dwordx8 s[4:11], s[0:1], 0
    s_load_dwordx4 s[12:15], s[0:1], 32
    s_cmp_ge_u32 s2, 256
    s_cbranch_scc1 L_end
    v_and_b32 v2, 63, v0
    v_lshrrev_b32 v3, 6, v0
    v_and_b32 v4, 15, v0
    v_bfe_u32 v5, v0, 4, 2
    v_mul_u32_u24 v1, 768, v5
    v_lshl_add_u32 v1, v4, 4, v1
    v_readfirstlane_b32 s3, v3
    v_lshlrev_b32 v6, 4, v0
    v_mul_u32_u24 v7, 768, v3
    v_lshl_add_u32 v7, v2, 3, v7
    v_lshlrev_b32 v3, 4, v2
    s_lshl_b32 s33, s2, 3
    s_add_u32 s33, s33, s3
    s_mul_i32 s33, s33, 3072
    s_lshr_b32 s37, s2, 1
    s_lshl_b32 s37, s37, 3
    s_add_u32 s37, s37, s3
    s_mul_i32 s37, s37, 3072
    s_add_u32 s37, s37, 88080384
    s_mov_b32 s18, 100663296
    s_mov_b32 s19, 0x00020000
    s_mov_b32 s22, 100663296
    s_mov_b32 s23, 0x00020000
    s_mov_b32 s26, 4608
    s_mov_b32 s27, 0x00020000
    s_mov_b32 s30, 4608
    s_mov_b32 s31, 0x00020000
    s_waitcnt lgkmcnt(0)
    s_mov_b32 s16, s4
    s_mov_b32 s17, s5
    s_mov_b32 s24, s6
    s_mov_b32 s25, s7
    s_mov_b32 s28, s8
    s_mov_b32 s29, s9
    s_mov_b32 s20, s10
    s_mov_b32 s21, s11
    s_add_u32 s32, s33, 0
    buffer_load_dwordx4 v[64:67], v1, s[16:19], s32 offen offset:0 nt
    buffer_load_dwordx4 v[68:71], v1, s[16:19], s32 offen offset:256 nt
    buffer_load_dwordx4 v[72:75], v1, s[16:19], s32 offen offset:512 nt
    s_add_u32 s32, s33, 6291456
    buffer_load_dwordx4 v[76:79], v1, s[16:19], s32 offen offset:0 nt
    buffer_load_dwordx4 v[80:83], v1, s[16:19], s32 offen offset:256 nt
    buffer_load_dwordx4 v[84:87], v1, s[16:19], s32 offen offset:512 nt
    buffer_load_dwordx4 v[48:51], v6, s[24:27], 0 offen
    buffer_load_dwordx2 v[52:53], v7, s[28:31], 0 offen
    buffer_load_dwordx2 v[54:55], v7, s[28:31], 0 offen offset:384
    s_add_u32 s4, s14, 16384
    s_addc_u32 s5, s15, 0
    s_add_u32 s6, s14, 20480
    s_addc_u32 s7, s15, 0
    v_mov_b32 v62, 0
    s_or_b32 s34, s2, s3
    s_cmp_lg_u32 s34, 0
    s_cbranch_scc1 L_noinit
    v_mov_b32 v8, 0
    v_mov_b32 v9, 0
    v_mov_b32 v10, 0
    v_mov_b32 v11, 0
    v_lshrrev_b32 v12, 2, v2
    v_lshlrev_b32 v12, 7, v12
    v_and_b32 v13, 3, v2
    v_lshl_add_u32 v12, v13, 4, v12
    global_store_dwordx4 v12, v[8:11], s[14:15] offset:0 sc1
    global_store_dwordx4 v12, v[8:11], s[14:15] offset:2048 sc1
    v_add_u32 v12, 4096, v12
    global_store_dwordx4 v12, v[8:11], s[14:15] offset:0 sc1
    global_store_dwordx4 v12, v[8:11], s[14:15] offset:2048 sc1
    global_store_dwordx4 v3, v[8:11], s[4:5] offset:0 sc1
    global_store_dwordx4 v3, v[8:11], s[4:5] offset:1024 sc1
    global_store_dwordx4 v3, v[8:11], s[4:5] offset:2048 sc1
    global_store_dwordx4 v3, v[8:11], s[4:5] offset:3072 sc1
    v_mov_b32 v13, 1
    s_waitcnt vmcnt(0)
    s_mov_b64 exec, 1
    global_store_dword v62, v13, s[12:13] sc1
    s_mov_b64 exec, -1
L_noinit:
    v_and_b32 v16, 1, v4
    v_cmp_eq_u32 vcc, 1, v16
    v_mov_b32 v17, 0x3f80
    v_mov_b32 v18, 0x3f800000
    v_cndmask_b32 v17, v17, v18, vcc
    v_lshrrev_b32 v16, 1, v4
    v_cmp_eq_u32 vcc, 0, v16
    s_nop 1
    v_cndmask_b32 v8, 0, v17, vcc
    v_cmp_eq_u32 vcc, 1, v16
    s_nop 1
    v_cndmask_b32 v9, 0, v17, vcc
    v_cmp_eq_u32 vcc, 2, v16
    s_nop 1
    v_cndmask_b32 v10, 0, v17, vcc
    v_cmp_eq_u32 vcc, 3, v16
    s_nop 1
    v_cndmask_b32 v11, 0, v17, vcc
    v_cmp_eq_u32 vcc, 4, v16
    s_nop 1
    v_cndmask_b32 v12, 0, v17, vcc
    v_cmp_eq_u32 vcc, 5, v16
    s_nop 1
    v_cndmask_b32 v13, 0, v17, vcc
    v_cmp_eq_u32 vcc, 6, v16
    s_nop 1
    v_cndmask_b32 v14, 0, v17, vcc
    v_cmp_eq_u32 vcc, 7, v16
    s_nop 1
    v_cndmask_b32 v15, 0, v17, vcc
    v_mov_b32 v16, 0
    v_mov_b32 v17, 0
    v_mov_b32 v18, 0
    v_mov_b32 v19, 0
    v_mov_b32 v20, 0
    v_mov_b32 v21, 0
    v_mov_b32 v22, 0
    v_mov_b32 v23, 0
    v_mov_b32 v24, 0
    v_mov_b32 v25, 0
    v_mov_b32 v26, 0
    v_mov_b32 v27, 0
    v_mov_b32 v28, 0x3e000000
    v_lshrrev_b32 v60, 1, v5
    v_lshlrev_b32 v60, 5, v60
    v_lshl_add_u32 v60, v4, 1, v60
    v_and_b32 v61, 1, v5
    v_add_u32 v60, v60, v61
    v_mul_u32_u24 v61, 43, v60
    v_lshrrev_b32 v61, 7, v61
    v_add_u32 v61, v60, v61
    v_lshlrev_b32 v63, 2, v60
    v_subrev_u32 v63, 189, v63
    v_cmp_gt_u32 vcc, 48, v60
    s_nop 1
    v_cndmask_b32 v60, v63, v61, vcc
    v_lshlrev_b32 v60, 4, v60
    s_lshl_b32 s34, s3, 10
    v_add_u32 v60, s34, v60
    s_mul_i32 s34, s3, 6144
    s_add_u32 s34, s34, 28672
    v_add_u32 v0, s34, v3
    s_bitcmp1_b32 s2, 0
    s_cbranch_scc1 L_acc_odd
    s_add_u32 s32, s33, 12582912
    s_waitcnt vmcnt(8)
    v_mfma_f32_16x16x32_bf16 v[16:19], v[8:11], v[64:67], v[16:19]
    ds_write_b128 v0, v[64:67] offset:0
    s_waitcnt vmcnt(7)
    v_mfma_f32_16x16x32_bf16 v[16:19], v[12:15], v[68:71], v[16:19]
    v_mfma_f32_16x16x32_bf16 v[24:27], v[8:11], v[68:71], v[24:27]
    ds_write_b128 v0, v[68:71] offset:1024
    s_waitcnt vmcnt(6)
    v_mfma_f32_16x16x32_bf16 v[24:27], v[12:15], v[72:75], v[24:27]
    v_mfma_f32_16x16x32_bf16 v[20:23], v[8:11], v[72:75], v[20:23]
    ds_write_b128 v0, v[72:75] offset:2048
    s_waitcnt vmcnt(5)
    buffer_load_dwordx4 v[88:91], v1, s[16:19], s32 offen offset:0 nt
    v_mfma_f32_16x16x32_bf16 v[16:19], v[8:11], v[76:79], v[16:19]
    ds_write_b128 v0, v[76:79] offset:3072
    s_waitcnt vmcnt(5)
    buffer_load_dwordx4 v[92:95], v1, s[16:19], s32 offen offset:256 nt
    v_mfma_f32_16x16x32_bf16 v[16:19], v[12:15], v[80:83], v[16:19]
    v_mfma_f32_16x16x32_bf16 v[24:27], v[8:11], v[80:83], v[24:27]
    ds_write_b128 v0, v[80:83] offset:4096
    s_waitcnt vmcnt(5)
    buffer_load_dwordx4 v[96:99], v1, s[16:19], s32 offen offset:512 nt
    v_mfma_f32_16x16x32_bf16 v[24:27], v[12:15], v[84:87], v[24:27]
    v_mfma_f32_16x16x32_bf16 v[20:23], v[8:11], v[84:87], v[20:23]
    ds_write_b128 v0, v[84:87] offset:5120
    s_add_u32 s32, s33, 18874368
    s_waitcnt vmcnt(2)
    buffer_load_dwordx4 v[100:103], v1, s[16:19], s32 offen offset:0 nt
    v_mfma_f32_16x16x32_bf16 v[16:19], v[8:11], v[88:91], v[16:19]
    s_mov_b32 s34, 0x05040100
    s_mov_b32 s35, 0x07060302
    ds_write_b128 v6, v[48:51] offset:12288
    v_perm_b32 v56, v54, v52, s34
    v_perm_b32 v57, v54, v52, s35
    v_perm_b32 v58, v55, v53, s34
    v_perm_b32 v59, v55, v53, s35
    ds_write_b128 v6, v[56:59] offset:20480
    v_add_u32 v61, 16, v4
    v_subrev_u32 v63, 24, v61
    v_min_u32 v61, v61, v63
    v_lshlrev_b32 v7, 5, v61
    v_add_u32 v7, 9216, v7
    v_lshlrev_b32 v6, 5, v4
    v_add_u32 v6, 9216, v6
    s_waitcnt vmcnt(2)
    buffer_load_dwordx4 v[104:107], v1, s[16:19], s32 offen offset:256 nt
    v_mfma_f32_16x16x32_bf16 v[16:19], v[12:15], v[92:95], v[16:19]
    v_mfma_f32_16x16x32_bf16 v[24:27], v[8:11], v[92:95], v[24:27]
    s_waitcnt vmcnt(2)
    buffer_load_dwordx4 v[108:111], v1, s[16:19], s32 offen offset:512 nt
    v_mfma_f32_16x16x32_bf16 v[24:27], v[12:15], v[96:99], v[24:27]
    v_mfma_f32_16x16x32_bf16 v[20:23], v[8:11], v[96:99], v[20:23]
    s_add_u32 s32, s33, 25165824
    s_waitcnt vmcnt(2)
    buffer_load_dwordx4 v[112:115], v1, s[16:19], s32 offen offset:0 nt
    v_mfma_f32_16x16x32_bf16 v[16:19], v[8:11], v[100:103], v[16:19]
    v_lshlrev_b32 v59, 2, v2
    s_lshr_b32 s34, s2, 3
    s_and_b32 s34, s34, 3
    s_lshl_b32 s35, s34, 11
    v_lshlrev_b32 v48, 7, v5
    v_lshl_add_u32 v48, v4, 2, v48
    v_add_u32 v48, s35, v48
    s_lshl_b32 s35, s34, 10
    v_add_u32 v49, s35, v59
    v_mul_u32_u24 v63, 192, v5
    v_lshrrev_b32 v58, 2, v4
    v_mad_u32_u24 v63, v58, 24, v63
    v_and_b32 v58, 3, v4
    v_lshl_add_u32 v63, v58, 3, v63
    v_mov_b32 v58, 63.0
    s_mov_b32 s36, 8192
    s_mov_b32 s8, 0x1fff1fff
    s_mov_b32 s9, 0x1fff1fff
    s_mov_b32 s10, 0x0fff0fff
    s_mov_b32 s11, 0x0fff0fff
    s_mov_b32 s76, 0x36800000
    s_mov_b32 s77, 0x36800000
    s_mov_b32 s78, 0xbfb8aa3b
    s_mov_b32 s79, 0xbfb8aa3b
    s_mov_b64 s[72:73], -1
    s_waitcnt vmcnt(2)
    buffer_load_dwordx4 v[116:119], v1, s[16:19], s32 offen offset:256 nt
    v_mfma_f32_16x16x32_bf16 v[16:19], v[12:15], v[104:107], v[16:19]
    v_mfma_f32_16x16x32_bf16 v[24:27], v[8:11], v[104:107], v[24:27]
    s_waitcnt vmcnt(2)
    buffer_load_dwordx4 v[120:123], v1, s[16:19], s32 offen offset:512 nt
    v_mfma_f32_16x16x32_bf16 v[24:27], v[12:15], v[108:111], v[24:27]
    v_mfma_f32_16x16x32_bf16 v[20:23], v[8:11], v[108:111], v[20:23]
    s_add_u32 s32, s33, 31457280
    s_waitcnt vmcnt(2)
    buffer_load_dwordx4 v[124:127], v1, s[16:19], s32 offen offset:0 nt
    v_mfma_f32_16x16x32_bf16 v[16:19], v[8:11], v[112:115], v[16:19]
    s_waitcnt vmcnt(2)
    buffer_load_dwordx4 v[128:131], v1, s[16:19], s32 offen offset:256 nt
    v_mfma_f32_16x16x32_bf16 v[16:19], v[12:15], v[116:119], v[16:19]
    v_mfma_f32_16x16x32_bf16 v[24:27], v[8:11], v[116:119], v[24:27]
    s_waitcnt vmcnt(2)
    buffer_load_dwordx4 v[132:135], v1, s[16:19], s32 offen offset:512 nt
    v_mfma_f32_16x16x32_bf16 v[24:27], v[12:15], v[120:123], v[24:27]
    v_mfma_f32_16x16x32_bf16 v[20:23], v[8:11], v[120:123], v[20:23]
    s_add_u32 s32, s33, 37748736
    s_waitcnt vmcnt(2)
    buffer_load_dwordx4 v[136:139], v1, s[16:19], s32 offen offset:0 nt
    v_mfma_f32_16x16x32_bf16 v[16:19], v[8:11], v[124:127], v[16:19]
    s_waitcnt vmcnt(2)
    buffer_load_dwordx4 v[140:143], v1, s[16:19], s32 offen offset:256 nt
    v_mfma_f32_16x16x32_bf16 v[16:19], v[12:15], v[128:131], v[16:19]
    v_mfma_f32_16x16x32_bf16 v[24:27], v[8:11], v[128:131], v[24:27]
    s_waitcnt vmcnt(2)
    buffer_load_dwordx4 v[144:147], v1, s[16:19], s32 offen offset:512 nt
    v_mfma_f32_16x16x32_bf16 v[24:27], v[12:15], v[132:135], v[24:27]
    v_mfma_f32_16x16x32_bf16 v[20:23], v[8:11], v[132:135], v[20:23]
    s_add_u32 s32, s33, 44040192
    s_waitcnt vmcnt(2)
    buffer_load_dwordx4 v[148:151], v1, s[16:19], s32 offen offset:0 nt
    v_mfma_f32_16x16x32_bf16 v[16:19], v[8:11], v[136:139], v[16:19]
    s_waitcnt vmcnt(2)
    buffer_load_dwordx4 v[152:155], v1, s[16:19], s32 offen offset:256 nt
    v_mfma_f32_16x16x32_bf16 v[16:19], v[12:15], v[140:143], v[16:19]
    v_mfma_f32_16x16x32_bf16 v[24:27], v[8:11], v[140:143], v[24:27]
    s_waitcnt vmcnt(2)
    buffer_load_dwordx4 v[156:159], v1, s[16:19], s32 offen offset:512 nt
    v_mfma_f32_16x16x32_bf16 v[24:27], v[12:15], v[144:147], v[24:27]
    v_mfma_f32_16x16x32_bf16 v[20:23], v[8:11], v[144:147], v[20:23]
    s_add_u32 s32, s33, 50331648
    s_waitcnt vmcnt(2)
    buffer_load_dwordx4 v[160:163], v1, s[16:19], s32 offen offset:0 nt
    v_mfma_f32_16x16x32_bf16 v[16:19], v[8:11], v[148:151], v[16:19]
    s_waitcnt vmcnt(2)
    buffer_load_dwordx4 v[164:167], v1, s[16:19], s32 offen offset:256 nt
    v_mfma_f32_16x16x32_bf16 v[16:19], v[12:15], v[152:155], v[16:19]
    v_mfma_f32_16x16x32_bf16 v[24:27], v[8:11], v[152:155], v[24:27]
    s_waitcnt vmcnt(2)
    buffer_load_dwordx4 v[168:171], v1, s[16:19], s32 offen offset:512 nt
    v_mfma_f32_16x16x32_bf16 v[24:27], v[12:15], v[156:159], v[24:27]
    v_mfma_f32_16x16x32_bf16 v[20:23], v[8:11], v[156:159], v[20:23]
    s_add_u32 s32, s33, 56623104
    s_waitcnt vmcnt(2)
    buffer_load_dwordx4 v[172:175], v1, s[16:19], s32 offen offset:0 nt
    v_mfma_f32_16x16x32_bf16 v[16:19], v[8:11], v[160:163], v[16:19]
    s_waitcnt vmcnt(2)
    buffer_load_dwordx4 v[176:179], v1, s[16:19], s32 offen offset:256 nt
    v_mfma_f32_16x16x32_bf16 v[16:19], v[12:15], v[164:167], v[16:19]
    v_mfma_f32_16x16x32_bf16 v[24:27], v[8:11], v[164:167], v[24:27]
    s_waitcnt vmcnt(2)
    buffer_load_dwordx4 v[180:183], v1, s[16:19], s32 offen offset:512 nt
    v_mfma_f32_16x16x32_bf16 v[24:27], v[12:15], v[168:171], v[24:27]
    v_mfma_f32_16x16x32_bf16 v[20:23], v[8:11], v[168:171], v[20:23]
    s_add_u32 s32, s33, 62914560
    s_waitcnt vmcnt(2)
    buffer_load_dwordx4 v[184:187], v1, s[16:19], s32 offen offset:0 nt
    v_mfma_f32_16x16x32_bf16 v[16:19], v[8:11], v[172:175], v[16:19]
    s_waitcnt vmcnt(2)
    buffer_load_dwordx4 v[188:191], v1, s[16:19], s32 offen offset:256 nt
    v_mfma_f32_16x16x32_bf16 v[16:19], v[12:15], v[176:179], v[16:19]
    v_mfma_f32_16x16x32_bf16 v[24:27], v[8:11], v[176:179], v[24:27]
    s_waitcnt vmcnt(2)
    buffer_load_dwordx4 v[192:195], v1, s[16:19], s32 offen offset:512 nt
    v_mfma_f32_16x16x32_bf16 v[24:27], v[12:15], v[180:183], v[24:27]
    v_mfma_f32_16x16x32_bf16 v[20:23], v[8:11], v[180:183], v[20:23]
    s_add_u32 s32, s33, 69206016
    s_waitcnt vmcnt(2)
    buffer_load_dwordx4 v[196:199], v1, s[16:19], s32 offen offset:0 nt
    v_mfma_f32_16x16x32_bf16 v[16:19], v[8:11], v[184:187], v[16:19]
    s_waitcnt vmcnt(2)
    buffer_load_dwordx4 v[200:203], v1, s[16:19], s32 offen offset:256 nt
    v_mfma_f32_16x16x32_bf16 v[16:19], v[12:15], v[188:191], v[16:19]
    v_mfma_f32_16x16x32_bf16 v[24:27], v[8:11], v[188:191], v[24:27]
    s_waitcnt vmcnt(2)
    buffer_load_dwordx4 v[204:207], v1, s[16:19], s32 offen offset:512 nt
    v_mfma_f32_16x16x32_bf16 v[24:27], v[12:15], v[192:195], v[24:27]
    v_mfma_f32_16x16x32_bf16 v[20:23], v[8:11], v[192:195], v[20:23]
    s_add_u32 s32, s33, 75497472
    s_waitcnt vmcnt(2)
    buffer_load_dwordx4 v[208:211], v1, s[16:19], s32 offen offset:0 nt
    v_mfma_f32_16x16x32_bf16 v[16:19], v[8:11], v[196:199], v[16:19]
    s_waitcnt vmcnt(2)
    buffer_load_dwordx4 v[212:215], v1, s[16:19], s32 offen offset:256 nt
    v_mfma_f32_16x16x32_bf16 v[16:19], v[12:15], v[200:203], v[16:19]
    v_mfma_f32_16x16x32_bf16 v[24:27], v[8:11], v[200:203], v[24:27]
    s_waitcnt vmcnt(2)
    buffer_load_dwordx4 v[216:219], v1, s[16:19], s32 offen offset:512 nt
    v_mfma_f32_16x16x32_bf16 v[24:27], v[12:15], v[204:207], v[24:27]
    v_mfma_f32_16x16x32_bf16 v[20:23], v[8:11], v[204:207], v[20:23]
    s_add_u32 s32, s33, 81788928
    s_waitcnt vmcnt(2)
    buffer_load_dwordx4 v[220:223], v1, s[16:19], s32 offen offset:0 nt
    v_mfma_f32_16x16x32_bf16 v[16:19], v[8:11], v[208:211], v[16:19]
    s_waitcnt vmcnt(2)
    buffer_load_dwordx4 v[224:227], v1, s[16:19], s32 offen offset:256 nt
    v_mfma_f32_16x16x32_bf16 v[16:19], v[12:15], v[212:215], v[16:19]
    v_mfma_f32_16x16x32_bf16 v[24:27], v[8:11], v[212:215], v[24:27]
    s_waitcnt vmcnt(2)
    buffer_load_dwordx4 v[228:231], v1, s[16:19], s32 offen offset:512 nt
    v_mfma_f32_16x16x32_bf16 v[24:27], v[12:15], v[216:219], v[24:27]
    v_mfma_f32_16x16x32_bf16 v[20:23], v[8:11], v[216:219], v[20:23]
    s_add_u32 s32, s37, 0
    s_waitcnt vmcnt(2)
    buffer_load_dwordx4 v[232:235], v1, s[16:19], s32 offen offset:0 nt
    v_mfma_f32_16x16x32_bf16 v[16:19], v[8:11], v[220:223], v[16:19]
    s_waitcnt vmcnt(2)
    buffer_load_dwordx4 v[236:239], v1, s[16:19], s32 offen offset:256 nt
    v_mfma_f32_16x16x32_bf16 v[16:19], v[12:15], v[224:227], v[16:19]
    v_mfma_f32_16x16x32_bf16 v[24:27], v[8:11], v[224:227], v[24:27]
    s_waitcnt vmcnt(2)
    buffer_load_dwordx4 v[240:243], v1, s[16:19], s32 offen offset:512 nt
    v_mfma_f32_16x16x32_bf16 v[24:27], v[12:15], v[228:231], v[24:27]
    v_mfma_f32_16x16x32_bf16 v[20:23], v[8:11], v[228:231], v[20:23]
    s_add_u32 s32, s37, 3145728
    s_waitcnt vmcnt(2)
    buffer_load_dwordx4 v[244:247], v1, s[16:19], s32 offen offset:0 nt
    v_mfma_f32_16x16x32_bf16 v[16:19], v[8:11], v[232:235], v[16:19]
    s_waitcnt vmcnt(2)
    buffer_load_dwordx4 v[248:251], v1, s[16:19], s32 offen offset:256 nt
    v_mfma_f32_16x16x32_bf16 v[16:19], v[12:15], v[236:239], v[16:19]
    v_mfma_f32_16x16x32_bf16 v[24:27], v[8:11], v[236:239], v[24:27]
    s_waitcnt vmcnt(2)
    buffer_load_dwordx4 v[252:255], v1, s[16:19], s32 offen offset:512 nt
    v_mfma_f32_16x16x32_bf16 v[24:27], v[12:15], v[240:243], v[24:27]
    v_mfma_f32_16x16x32_bf16 v[20:23], v[8:11], v[240:243], v[20:23]
    s_add_u32 s32, s37, 6291456
    s_waitcnt lgkmcnt(0)
    buffer_load_dwordx4 v[64:67], v1, s[16:19], s32 offen offset:0 nt
    s_waitcnt lgkmcnt(0)
    buffer_load_dwordx4 v[68:71], v1, s[16:19], s32 offen offset:256 nt
    s_waitcnt lgkmcnt(0)
    buffer_load_dwordx4 v[72:75], v1, s[16:19], s32 offen offset:512 nt
    s_add_u32 s32, s37, 9437184
    s_waitcnt lgkmcnt(0)
    buffer_load_dwordx4 v[76:79], v1, s[16:19], s32 offen offset:0 nt
    s_waitcnt lgkmcnt(0)
    buffer_load_dwordx4 v[80:83], v1, s[16:19], s32 offen offset:256 nt
    s_waitcnt lgkmcnt(0)
    buffer_load_dwordx4 v[84:87], v1, s[16:19], s32 offen offset:512 nt
    global_load_dword v61, v62, s[12:13] sc1
    s_waitcnt vmcnt(9)
    v_mfma_f32_16x16x32_bf16 v[16:19], v[8:11], v[244:247], v[16:19]
    s_waitcnt vmcnt(8)
    v_mfma_f32_16x16x32_bf16 v[16:19], v[12:15], v[248:251], v[16:19]
    v_mfma_f32_16x16x32_bf16 v[24:27], v[8:11], v[248:251], v[24:27]
    s_waitcnt vmcnt(7)
    v_mfma_f32_16x16x32_bf16 v[24:27], v[12:15], v[252:255], v[24:27]
    v_mfma_f32_16x16x32_bf16 v[20:23], v[8:11], v[252:255], v[20:23]
    s_waitcnt vmcnt(6)
    v_mfma_f32_16x16x32_bf16 v[16:19], v[8:11], v[64:67], v[16:19]
    s_waitcnt vmcnt(5)
    v_mfma_f32_16x16x32_bf16 v[16:19], v[12:15], v[68:71], v[16:19]
    v_mfma_f32_16x16x32_bf16 v[24:27], v[8:11], v[68:71], v[24:27]
    s_waitcnt vmcnt(4)
    v_mfma_f32_16x16x32_bf16 v[24:27], v[12:15], v[72:75], v[24:27]
    v_mfma_f32_16x16x32_bf16 v[20:23], v[8:11], v[72:75], v[20:23]
    s_waitcnt vmcnt(3)
    v_mfma_f32_16x16x32_bf16 v[16:19], v[8:11], v[76:79], v[16:19]
    s_waitcnt vmcnt(2)
    v_mfma_f32_16x16x32_bf16 v[16:19], v[12:15], v[80:83], v[16:19]
    v_mfma_f32_16x16x32_bf16 v[24:27], v[8:11], v[80:83], v[24:27]
    s_waitcnt vmcnt(1)
    v_mfma_f32_16x16x32_bf16 v[24:27], v[12:15], v[84:87], v[24:27]
    v_mfma_f32_16x16x32_bf16 v[20:23], v[8:11], v[84:87], v[20:23]
    s_branch L_acc_done
L_acc_odd:
    s_add_u32 s32, s33, 12582912
    s_waitcnt vmcnt(8)
    v_mfma_f32_16x16x32_bf16 v[16:19], v[8:11], v[64:67], v[16:19]
    s_waitcnt vmcnt(7)
    v_mfma_f32_16x16x32_bf16 v[16:19], v[12:15], v[68:71], v[16:19]
    v_mfma_f32_16x16x32_bf16 v[24:27], v[8:11], v[68:71], v[24:27]
    s_waitcnt vmcnt(6)
    v_mfma_f32_16x16x32_bf16 v[24:27], v[12:15], v[72:75], v[24:27]
    v_mfma_f32_16x16x32_bf16 v[20:23], v[8:11], v[72:75], v[20:23]
    s_waitcnt vmcnt(5)
    buffer_load_dwordx4 v[88:91], v1, s[16:19], s32 offen offset:0 nt
    v_mfma_f32_16x16x32_bf16 v[16:19], v[8:11], v[76:79], v[16:19]
    s_waitcnt vmcnt(5)
    v_mfma_f32_16x16x32_bf16 v[16:19], v[12:15], v[80:83], v[16:19]
    v_mfma_f32_16x16x32_bf16 v[24:27], v[8:11], v[80:83], v[24:27]
    s_waitcnt vmcnt(4)
    buffer_load_dwordx4 v[92:95], v1, s[16:19], s32 offen offset:256 nt
    v_mfma_f32_16x16x32_bf16 v[24:27], v[12:15], v[84:87], v[24:27]
    v_mfma_f32_16x16x32_bf16 v[20:23], v[8:11], v[84:87], v[20:23]
    buffer_load_dwordx4 v[96:99], v1, s[16:19], s32 offen offset:512 nt
    s_add_u32 s32, s33, 18874368
    s_waitcnt vmcnt(2)
    v_mfma_f32_16x16x32_bf16 v[16:19], v[8:11], v[88:91], v[16:19]
    s_mov_b32 s34, 0x05040100
    s_mov_b32 s35, 0x07060302
    ds_write_b128 v6, v[48:51] offset:12288
    v_perm_b32 v56, v54, v52, s34
    v_perm_b32 v57, v54, v52, s35
    v_perm_b32 v58, v55, v53, s34
    v_perm_b32 v59, v55, v53, s35
    ds_write_b128 v6, v[56:59] offset:20480
    v_add_u32 v61, 16, v4
    v_subrev_u32 v63, 24, v61
    v_min_u32 v61, v61, v63
    v_lshlrev_b32 v7, 5, v61
    v_add_u32 v7, 9216, v7
    v_lshlrev_b32 v6, 5, v4
    v_add_u32 v6, 9216, v6
    s_waitcnt vmcnt(1)
    buffer_load_dwordx4 v[100:103], v1, s[16:19], s32 offen offset:0 nt
    v_mfma_f32_16x16x32_bf16 v[16:19], v[12:15], v[92:95], v[16:19]
    v_mfma_f32_16x16x32_bf16 v[24:27], v[8:11], v[92:95], v[24:27]
    buffer_load_dwordx4 v[104:107], v1, s[16:19], s32 offen offset:256 nt
    s_waitcnt vmcnt(2)
    v_mfma_f32_16x16x32_bf16 v[24:27], v[12:15], v[96:99], v[24:27]
    v_mfma_f32_16x16x32_bf16 v[20:23], v[8:11], v[96:99], v[20:23]
    s_waitcnt vmcnt(1)
    buffer_load_dwordx4 v[108:111], v1, s[16:19], s32 offen offset:512 nt
    v_mfma_f32_16x16x32_bf16 v[16:19], v[8:11], v[100:103], v[16:19]
    v_lshlrev_b32 v59, 2, v2
    s_lshr_b32 s34, s2, 3
    s_and_b32 s34, s34, 3
    s_lshl_b32 s35, s34, 11
    v_lshlrev_b32 v48, 7, v5
    v_lshl_add_u32 v48, v4, 2, v48
    v_add_u32 v48, s35, v48
    s_lshl_b32 s35, s34, 10
    v_add_u32 v49, s35, v59
    v_mul_u32_u24 v63, 192, v5
    v_lshrrev_b32 v58, 2, v4
    v_mad_u32_u24 v63, v58, 24, v63
    v_and_b32 v58, 3, v4
    v_lshl_add_u32 v63, v58, 3, v63
    v_mov_b32 v58, 63.0
    s_mov_b32 s36, 8192
    s_mov_b32 s8, 0x1fff1fff
    s_mov_b32 s9, 0x1fff1fff
    s_mov_b32 s10, 0x0fff0fff
    s_mov_b32 s11, 0x0fff0fff
    s_mov_b32 s76, 0x36800000
    s_mov_b32 s77, 0x36800000
    s_mov_b32 s78, 0xbfb8aa3b
    s_mov_b32 s79, 0xbfb8aa3b
    s_mov_b64 s[72:73], -1
    s_add_u32 s32, s33, 25165824
    buffer_load_dwordx4 v[112:115], v1, s[16:19], s32 offen offset:0 nt
    s_waitcnt vmcnt(2)
    v_mfma_f32_16x16x32_bf16 v[16:19], v[12:15], v[104:107], v[16:19]
    v_mfma_f32_16x16x32_bf16 v[24:27], v[8:11], v[104:107], v[24:27]
    s_waitcnt vmcnt(1)
    buffer_load_dwordx4 v[116:119], v1, s[16:19], s32 offen offset:256 nt
    v_mfma_f32_16x16x32_bf16 v[24:27], v[12:15], v[108:111], v[24:27]
    v_mfma_f32_16x16x32_bf16 v[20:23], v[8:11], v[108:111], v[20:23]
    buffer_load_dwordx4 v[120:123], v1, s[16:19], s32 offen offset:512 nt
    s_add_u32 s32, s33, 31457280
    s_waitcnt vmcnt(2)
    v_mfma_f32_16x16x32_bf16 v[16:19], v[8:11], v[112:115], v[16:19]
    s_waitcnt vmcnt(1)
    buffer_load_dwordx4 v[124:127], v1, s[16:19], s32 offen offset:0 nt
    v_mfma_f32_16x16x32_bf16 v[16:19], v[12:15], v[116:119], v[16:19]
    v_mfma_f32_16x16x32_bf16 v[24:27], v[8:11], v[116:119], v[24:27]
    buffer_load_dwordx4 v[128:131], v1, s[16:19], s32 offen offset:256 nt
    s_waitcnt vmcnt(2)
    v_mfma_f32_16x16x32_bf16 v[24:27], v[12:15], v[120:123], v[24:27]
    v_mfma_f32_16x16x32_bf16 v[20:23], v[8:11], v[120:123], v[20:23]
    s_waitcnt vmcnt(1)
    buffer_load_dwordx4 v[132:135], v1, s[16:19], s32 offen offset:512 nt
    v_mfma_f32_16x16x32_bf16 v[16:19], v[8:11], v[124:127], v[16:19]
    s_add_u32 s32, s33, 37748736
    buffer_load_dwordx4 v[136:139], v1, s[16:19], s32 offen offset:0 nt
    s_waitcnt vmcnt(2)
    v_mfma_f32_16x16x32_bf16 v[16:19], v[12:15], v[128:131], v[16:19]
    v_mfma_f32_16x16x32_bf16 v[24:27], v[8:11], v[128:131], v[24:27]
    s_waitcnt vmcnt(1)
    buffer_load_dwordx4 v[140:143], v1, s[16:19], s32 offen offset:256 nt
    v_mfma_f32_16x16x32_bf16 v[24:27], v[12:15], v[132:135], v[24:27]
    v_mfma_f32_16x16x32_bf16 v[20:23], v[8:11], v[132:135], v[20:23]
    buffer_load_dwordx4 v[144:147], v1, s[16:19], s32 offen offset:512 nt
    s_add_u32 s32, s33, 44040192
    s_waitcnt vmcnt(2)
    v_mfma_f32_16x16x32_bf16 v[16:19], v[8:11], v[136:139], v[16:19]
    s_waitcnt vmcnt(1)
    buffer_load_dwordx4 v[148:151], v1, s[16:19], s32 offen offset:0 nt
    v_mfma_f32_16x16x32_bf16 v[16:19], v[12:15], v[140:143], v[16:19]
    v_mfma_f32_16x16x32_bf16 v[24:27], v[8:11], v[140:143], v[24:27]
    buffer_load_dwordx4 v[152:155], v1, s[16:19], s32 offen offset:256 nt
    s_waitcnt vmcnt(2)
    v_mfma_f32_16x16x32_bf16 v[24:27], v[12:15], v[144:147], v[24:27]
    v_mfma_f32_16x16x32_bf16 v[20:23], v[8:11], v[144:147], v[20:23]
    s_waitcnt vmcnt(1)
    buffer_load_dwordx4 v[156:159], v1, s[16:19], s32 offen offset:512 nt
    v_mfma_f32_16x16x32_bf16 v[16:19], v[8:11], v[148:151], v[16:19]
    s_add_u32 s32, s33, 50331648
    buffer_load_dwordx4 v[160:163], v1, s[16:19], s32 offen offset:0 nt
    s_waitcnt vmcnt(2)
    v_mfma_f32_16x16x32_bf16 v[16:19], v[12:15], v[152:155], v[16:19]
    v_mfma_f32_16x16x32_bf16 v[24:27], v[8:11], v[152:155], v[24:27]
    s_waitcnt vmcnt(1)
    buffer_load_dwordx4 v[164:167], v1, s[16:19], s32 offen offset:256 nt
    v_mfma_f32_16x16x32_bf16 v[24:27], v[12:15], v[156:159], v[24:27]
    v_mfma_f32_16x16x32_bf16 v[20:23], v[8:11], v[156:159], v[20:23]
    buffer_load_dwordx4 v[168:171], v1, s[16:19], s32 offen offset:512 nt
    s_add_u32 s32, s33, 56623104
    s_waitcnt vmcnt(2)
    v_mfma_f32_16x16x32_bf16 v[16:19], v[8:11], v[160:163], v[16:19]
    s_waitcnt vmcnt(1)
    buffer_load_dwordx4 v[172:175], v1, s[16:19], s32 offen offset:0 nt
    v_mfma_f32_16x16x32_bf16 v[16:19], v[12:15], v[164:167], v[16:19]
    v_mfma_f32_16x16x32_bf16 v[24:27], v[8:11], v[164:167], v[24:27]
    buffer_load_dwordx4 v[176:179], v1, s[16:19], s32 offen offset:256 nt
    s_waitcnt vmcnt(2)
    v_mfma_f32_16x16x32_bf16 v[24:27], v[12:15], v[168:171], v[24:27]
    v_mfma_f32_16x16x32_bf16 v[20:23], v[8:11], v[168:171], v[20:23]
    s_waitcnt vmcnt(1)
    buffer_load_dwordx4 v[180:183], v1, s[16:19], s32 offen offset:512 nt
    v_mfma_f32_16x16x32_bf16 v[16:19], v[8:11], v[172:175], v[16:19]
    s_add_u32 s32, s33, 62914560
    buffer_load_dwordx4 v[184:187], v1, s[16:19], s32 offen offset:0 nt
    s_waitcnt vmcnt(2)
    v_mfma_f32_16x16x32_bf16 v[16:19], v[12:15], v[176:179], v[16:19]
    v_mfma_f32_16x16x32_bf16 v[24:27], v[8:11], v[176:179], v[24:27]
    s_waitcnt vmcnt(1)
    buffer_load_dwordx4 v[188:191], v1, s[16:19], s32 offen offset:256 nt
    v_mfma_f32_16x16x32_bf16 v[24:27], v[12:15], v[180:183], v[24:27]
    v_mfma_f32_16x16x32_bf16 v[20:23], v[8:11], v[180:183], v[20:23]
    buffer_load_dwordx4 v[192:195], v1, s[16:19], s32 offen offset:512 nt
    s_add_u32 s32, s33, 69206016
    s_waitcnt vmcnt(2)
    v_mfma_f32_16x16x32_bf16 v[16:19], v[8:11], v[184:187], v[16:19]
    s_waitcnt vmcnt(1)
    buffer_load_dwordx4 v[196:199], v1, s[16:19], s32 offen offset:0 nt
    v_mfma_f32_16x16x32_bf16 v[16:19], v[12:15], v[188:191], v[16:19]
    v_mfma_f32_16x16x32_bf16 v[24:27], v[8:11], v[188:191], v[24:27]
    buffer_load_dwordx4 v[200:203], v1, s[16:19], s32 offen offset:256 nt
    s_waitcnt vmcnt(2)
    v_mfma_f32_16x16x32_bf16 v[24:27], v[12:15], v[192:195], v[24:27]
    v_mfma_f32_16x16x32_bf16 v[20:23], v[8:11], v[192:195], v[20:23]
    s_waitcnt vmcnt(1)
    buffer_load_dwordx4 v[204:207], v1, s[16:19], s32 offen offset:512 nt
    v_mfma_f32_16x16x32_bf16 v[16:19], v[8:11], v[196:199], v[16:19]
    s_add_u32 s32, s33, 75497472
    buffer_load_dwordx4 v[208:211], v1, s[16:19], s32 offen offset:0 nt
    s_waitcnt vmcnt(2)
    v_mfma_f32_16x16x32_bf16 v[16:19], v[12:15], v[200:203], v[16:19]
    v_mfma_f32_16x16x32_bf16 v[24:27], v[8:11], v[200:203], v[24:27]
    s_waitcnt vmcnt(1)
    buffer_load_dwordx4 v[212:215], v1, s[16:19], s32 offen offset:256 nt
    v_mfma_f32_16x16x32_bf16 v[24:27], v[12:15], v[204:207], v[24:27]
    v_mfma_f32_16x16x32_bf16 v[20:23], v[8:11], v[204:207], v[20:23]
    buffer_load_dwordx4 v[216:219], v1, s[16:19], s32 offen offset:512 nt
    s_add_u32 s32, s33, 81788928
    buffer_load_dwordx4 v[220:223], v1, s[16:19], s32 offen offset:0 nt
    buffer_load_dwordx4 v[224:227], v1, s[16:19], s32 offen offset:256 nt
    buffer_load_dwordx4 v[228:231], v1, s[16:19], s32 offen offset:512 nt
    global_load_dword v61, v62, s[12:13] sc1
    s_waitcnt vmcnt(6)
    v_mfma_f32_16x16x32_bf16 v[16:19], v[8:11], v[208:211], v[16:19]
    s_waitcnt vmcnt(5)
    v_mfma_f32_16x16x32_bf16 v[16:19], v[12:15], v[212:215], v[16:19]
    v_mfma_f32_16x16x32_bf16 v[24:27], v[8:11], v[212:215], v[24:27]
    s_waitcnt vmcnt(4)
    v_mfma_f32_16x16x32_bf16 v[24:27], v[12:15], v[216:219], v[24:27]
    v_mfma_f32_16x16x32_bf16 v[20:23], v[8:11], v[216:219], v[20:23]
    s_waitcnt vmcnt(3)
    v_mfma_f32_16x16x32_bf16 v[16:19], v[8:11], v[220:223], v[16:19]
    s_waitcnt vmcnt(2)
    v_mfma_f32_16x16x32_bf16 v[16:19], v[12:15], v[224:227], v[16:19]
    v_mfma_f32_16x16x32_bf16 v[24:27], v[8:11], v[224:227], v[24:27]
    s_waitcnt vmcnt(1)
    v_mfma_f32_16x16x32_bf16 v[24:27], v[12:15], v[228:231], v[24:27]
    v_mfma_f32_16x16x32_bf16 v[20:23], v[8:11], v[228:231], v[20:23]
L_acc_done:
    s_nop 6
    v_add_f32_dpp v16, v24, v16 row_ror:8 row_mask:0xf bank_mask:0x3
    v_add_f32_dpp v17, v25, v17 row_ror:8 row_mask:0xf bank_mask:0x3
    v_add_f32_dpp v18, v26, v18 row_ror:8 row_mask:0xf bank_mask:0x3
    v_add_f32_dpp v19, v27, v19 row_ror:8 row_mask:0xf bank_mask:0x3
    v_add_f32_dpp v16, v20, v16 row_ror:8 row_mask:0x3 bank_mask:0xc
    v_add_f32_dpp v17, v21, v17 row_ror:8 row_mask:0x3 bank_mask:0xc
    v_add_f32_dpp v18, v22, v18 row_ror:8 row_mask:0x3 bank_mask:0xc
    v_add_f32_dpp v19, v23, v19 row_ror:8 row_mask:0x3 bank_mask:0xc
    v_mov_b32_dpp v16, v28 quad_perm:[0,1,2,3] row_mask:0xc bank_mask:0xc
    ds_write_b128 v60, v[16:19] offset:0
    s_waitcnt lgkmcnt(0)
    s_barrier
    s_cmp_lg_u32 s3, 0
    s_cbranch_scc1 L_others
    ds_read2st64_b32 v[8:9], v59 offset0:0 offset1:4
    ds_read2st64_b32 v[10:11], v59 offset0:8 offset1:12
    ds_read2st64_b32 v[12:13], v59 offset0:16 offset1:20
    ds_read2st64_b32 v[14:15], v59 offset0:24 offset1:28
    s_setprio 3
    ds_read2st64_b32 v[16:17], v59 offset0:1 offset1:5
    ds_read2st64_b32 v[18:19], v59 offset0:9 offset1:13
    ds_read2st64_b32 v[20:21], v59 offset0:17 offset1:21
    ds_read2st64_b32 v[22:23], v59 offset0:25 offset1:29
    ds_read2st64_b32 v[24:25], v59 offset0:2 offset1:6
    ds_read2st64_b32 v[26:27], v59 offset0:10 offset1:14
    ds_read2st64_b32 v[28:29], v59 offset0:18 offset1:22
    ds_read2st64_b32 v[30:31], v59 offset0:26 offset1:30
    ds_read2st64_b32 v[32:33], v59 offset0:3 offset1:7
    ds_read2st64_b32 v[34:35], v59 offset0:11 offset1:15
    ds_read2st64_b32 v[36:37], v59 offset0:19 offset1:23
    ds_read2st64_b32 v[38:39], v59 offset0:27 offset1:31
L_flagcheck:
    s_waitcnt vmcnt(0)
    v_readfirstlane_b32 s35, v61
    s_cmp_lg_u32 s35, 0
    s_cbranch_scc1 L_flagok
    s_sub_u32 s36, s36, 1
    s_cbranch_scc1 L_fallback
    s_sleep 4
    global_load_dword v61, v62, s[12:13] sc1
    s_branch L_flagcheck
L_flagok:
    s_mov_b64 exec, s[8:9]
    s_waitcnt lgkmcnt(12)
    v_pk_add_f32 v[8:9], v[8:9], v[10:11]
    v_pk_add_f32 v[12:13], v[12:13], v[14:15]
    v_pk_add_f32 v[8:9], v[8:9], v[12:13]
    v_add_f32 v50, v8, v9
    global_atomic_add_f32 v54, v48, v50, s[14:15] offset:0 sc0
    s_waitcnt lgkmcnt(8)
    v_pk_add_f32 v[16:17], v[16:17], v[18:19]
    v_pk_add_f32 v[20:21], v[20:21], v[22:23]
    v_pk_add_f32 v[16:17], v[16:17], v[20:21]
    v_add_f32 v51, v16, v17
    global_atomic_add_f32 v55, v48, v51, s[14:15] offset:512 sc0
    s_waitcnt lgkmcnt(4)
    v_pk_add_f32 v[24:25], v[24:25], v[26:27]
    v_pk_add_f32 v[28:29], v[28:29], v[30:31]
    v_pk_add_f32 v[24:25], v[24:25], v[28:29]
    v_add_f32 v52, v24, v25
    global_atomic_add_f32 v56, v48, v52, s[14:15] offset:1024 sc0
    s_waitcnt lgkmcnt(0)
    v_pk_add_f32 v[32:33], v[32:33], v[34:35]
    v_pk_add_f32 v[36:37], v[36:37], v[38:39]
    v_pk_add_f32 v[32:33], v[32:33], v[36:37]
    v_add_f32 v53, v32, v33
    global_atomic_add_f32 v57, v48, v53, s[14:15] offset:1536 sc0
    s_mov_b64 exec, -1
    ds_read_b64_tr_b16 v[24:25], v63 offset:12288
    ds_read_b64_tr_b16 v[26:27], v63 offset:12384
    ds_read_b64_tr_b16 v[28:29], v63 offset:13056
    ds_read_b64_tr_b16 v[30:31], v63 offset:13152
    ds_read_b64_tr_b16 v[32:33], v63 offset:13824
    ds_read_b64_tr_b16 v[34:35], v63 offset:13920
    ds_read_b64_tr_b16 v[36:37], v63 offset:14592
    ds_read_b64_tr_b16 v[38:39], v63 offset:14688
    ds_read_b64_tr_b16 v[40:41], v63 offset:15360
    ds_read_b64_tr_b16 v[42:43], v63 offset:15456
    ds_read_b64_tr_b16 v[44:45], v63 offset:16128
    ds_read_b64_tr_b16 v[46:47], v63 offset:16224
    v_lshrrev_b32 v60, 1, v3
    v_lshrrev_b32 v61, 6, v3
    v_lshlrev_b32 v61, 3, v61
    v_sub_u32 v60, v60, v61
    v_lshlrev_b32 v61, 4, v5
    s_mov_b32 s36, 8192
    s_waitcnt vmcnt(0)
    v_mov_b32_dpp v8, v54 row_newbcast:12 row_mask:0xf bank_mask:0xf
    v_mov_b32_dpp v9, v55 row_newbcast:12 row_mask:0xf bank_mask:0xf
    v_mov_b32_dpp v10, v56 row_newbcast:12 row_mask:0xf bank_mask:0xf
    v_mov_b32_dpp v11, v57 row_newbcast:12 row_mask:0xf bank_mask:0xf
    v_cmp_eq_f32 s[64:65], v8, v58
    v_cmp_eq_f32 s[66:67], v9, v58
    v_cmp_eq_f32 s[68:69], v10, v58
    v_cmp_eq_f32 s[70:71], v11, v58
    s_and_b64 exec, s[64:65], s[10:11]
    s_cbranch_execz L_nopush0
    v_add_f32 v50, v50, v54
    v_or_b32 v50, 1, v50
    global_atomic_or v49, v50, s[4:5] offset:0
L_nopush0:
    s_and_b64 exec, s[66:67], s[10:11]
    s_cbranch_execz L_nopush1
    v_add_f32 v51, v51, v55
    v_or_b32 v51, 1, v51
    global_atomic_or v49, v51, s[4:5] offset:256
L_nopush1:
    s_and_b64 exec, s[68:69], s[10:11]
    s_cbranch_execz L_nopush2
    v_add_f32 v52, v52, v56
    v_or_b32 v52, 1, v52
    global_atomic_or v49, v52, s[4:5] offset:512
L_nopush2:
    s_and_b64 exec, s[70:71], s[10:11]
    s_cbranch_execz L_nopush3
    v_add_f32 v53, v53, v57
    v_or_b32 v53, 1, v53
    global_atomic_or v49, v53, s[4:5] offset:768
L_nopush3:
    s_mov_b32 exec_lo, 0x77777777
    s_mov_b32 exec_hi, 0x77777777
L_poll:
    global_load_dwordx4 v[8:11], v3, s[4:5] offset:0 sc1
    global_load_dwordx4 v[12:15], v3, s[4:5] offset:1024 sc1
    global_load_dwordx4 v[16:19], v3, s[4:5] offset:2048 sc1
    global_load_dwordx4 v[20:23], v3, s[4:5] offset:3072 sc1
    s_waitcnt vmcnt(3)
    v_and_b32 v2, v8, v9
    v_and_b32 v4, v10, v11
    s_waitcnt vmcnt(2)
    v_bitop3_b32 v2, v2, v12, v13 bitop3:0x80
    v_bitop3_b32 v4, v4, v14, v15 bitop3:0x80
    v_pk_add_f32 v[8:9], v[8:9], v[12:13]
    v_pk_add_f32 v[10:11], v[10:11], v[14:15]
    s_waitcnt vmcnt(1)
    v_bitop3_b32 v2, v2, v16, v17 bitop3:0x80
    v_bitop3_b32 v4, v4, v18, v19 bitop3:0x80
    v_pk_add_f32 v[8:9], v[8:9], v[16:17]
    v_pk_add_f32 v[10:11], v[10:11], v[18:19]
    s_waitcnt vmcnt(0)
    v_bitop3_b32 v2, v2, v20, v21 bitop3:0x80
    v_bitop3_b32 v4, v4, v22, v23 bitop3:0x80
    v_pk_add_f32 v[8:9], v[8:9], v[20:21]
    v_pk_add_f32 v[10:11], v[10:11], v[22:23]
    v_bitop3_b32 v2, v2, v4, 1 bitop3:0x80
    v_cmp_ne_u32 vcc, 1, v2
    s_cbranch_vccz L_pollok
    s_sub_u32 s36, s36, 1
    s_cbranch_scc0 L_poll
    s_mov_b64 exec, -1
    s_branch L_fallback
L_pollok:
L_mlp:
    v_pk_mul_f32 v[8:9], v[8:9], s[76:77]
    v_pk_mul_f32 v[10:11], v[10:11], s[76:77]
    v_cvt_pk_bf16_f32 v8, v8, v9
    v_cvt_pk_bf16_f32 v9, v10, v11
    ds_write_b64 v60, v[8:9] offset:8192
    s_mov_b64 exec, s[72:73]
    ds_read_b128 v[12:15], v61 offset:8192
    ds_read_b128 v[16:19], v61 offset:8256
    ds_read_b128 v[20:23], v61 offset:8320
    ds_read_b128 v[48:51], v61 offset:8384
    ds_read_b128 v[52:55], v61 offset:8448
    ds_read_b128 v[56:59], v61 offset:8512
    s_waitcnt lgkmcnt(5)
    v_mfma_f32_16x16x32_bf16 v[8:11], v[12:15], v[24:27], 0
    s_waitcnt lgkmcnt(4)
    v_mfma_f32_16x16x32_bf16 v[8:11], v[16:19], v[28:31], v[8:11]
    s_waitcnt lgkmcnt(3)
    v_mfma_f32_16x16x32_bf16 v[8:11], v[20:23], v[32:35], v[8:11]
    s_waitcnt lgkmcnt(2)
    v_mfma_f32_16x16x32_bf16 v[8:11], v[48:51], v[36:39], v[8:11]
    s_waitcnt lgkmcnt(1)
    v_mfma_f32_16x16x32_bf16 v[8:11], v[52:55], v[40:43], v[8:11]
    s_waitcnt lgkmcnt(0)
    v_mfma_f32_16x16x32_bf16 v[8:11], v[56:59], v[44:47], v[8:11]
    ds_read_b128 v[24:27], v3 offset:20480
    ds_read_b128 v[28:31], v3 offset:21504
    ds_read_b128 v[32:35], v3 offset:22528
    ds_read_b128 v[36:39], v3 offset:23552
    ds_read_b128 v[40:43], v3 offset:24576
    ds_read_b128 v[44:47], v3 offset:25600
    s_nop 1
    v_cvt_pk_bf16_f32 v8, v8, v8
    v_lshlrev_b32 v8, 16, v8
    v_mul_f32 v9, s78, v8
    v_exp_f32 v9, v9
    s_nop 0
    v_add_f32 v9, 1.0, v9
    v_rcp_f32 v9, v9
    s_nop 0
    v_mul_f32 v8, v8, v9
    s_nop 1
    v_mov_b32_dpp v9, v8 quad_perm:[1,0,3,2] row_mask:0xf bank_mask:0xf
    v_cvt_pk_bf16_f32 v8, v8, v9
    s_nop 0
    v_readlane_b32 s64, v8, 0
    v_readlane_b32 s65, v8, 2
    v_readlane_b32 s66, v8, 4
    v_readlane_b32 s67, v8, 6
    v_readlane_b32 s68, v8, 8
    v_readlane_b32 s69, v8, 10
    s_waitcnt lgkmcnt(0)
    v_dot2_f32_bf16 v12, v24, s64, 0
    v_dot2_f32_bf16 v13, v25, s64, 0
    v_dot2_f32_bf16 v14, v26, s64, 0
    v_dot2_f32_bf16 v15, v27, s64, 0
    v_dot2_f32_bf16 v12, v28, s65, v12
    v_dot2_f32_bf16 v13, v29, s65, v13
    v_dot2_f32_bf16 v14, v30, s65, v14
    v_dot2_f32_bf16 v15, v31, s65, v15
    v_dot2_f32_bf16 v12, v32, s66, v12
    v_dot2_f32_bf16 v13, v33, s66, v13
    v_dot2_f32_bf16 v14, v34, s66, v14
    v_dot2_f32_bf16 v15, v35, s66, v15
    v_dot2_f32_bf16 v12, v36, s67, v12
    v_dot2_f32_bf16 v13, v37, s67, v13
    v_dot2_f32_bf16 v14, v38, s67, v14
    v_dot2_f32_bf16 v15, v39, s67, v15
    v_dot2_f32_bf16 v12, v40, s68, v12
    v_dot2_f32_bf16 v13, v41, s68, v13
    v_dot2_f32_bf16 v14, v42, s68, v14
    v_dot2_f32_bf16 v15, v43, s68, v15
    v_dot2_f32_bf16 v12, v44, s69, v12
    v_dot2_f32_bf16 v13, v45, s69, v13
    v_dot2_f32_bf16 v14, v46, s69, v14
    v_dot2_f32_bf16 v15, v47, s69, v15
    s_nop 2
    v_cvt_pk_bf16_f32 v8, v12, v13
    v_cvt_pk_bf16_f32 v9, v14, v15
    v_lshlrev_b32 v12, 16, v8
    v_and_b32 v13, 0xffff0000, v8
    v_lshlrev_b32 v14, 16, v9
    v_and_b32 v15, 0xffff0000, v9
    v_pk_mul_f32 v[12:13], v[12:13], s[78:79]
    v_pk_mul_f32 v[14:15], v[14:15], s[78:79]
    v_exp_f32 v12, v12
    v_exp_f32 v13, v13
    v_exp_f32 v14, v14
    v_exp_f32 v15, v15
    s_nop 0
    v_add_f32 v12, 1.0, v12
    v_add_f32 v13, 1.0, v13
    v_add_f32 v14, 1.0, v14
    v_add_f32 v15, 1.0, v15
    v_rcp_f32 v12, v12
    v_rcp_f32 v13, v13
    v_rcp_f32 v14, v14
    v_rcp_f32 v15, v15
    s_nop 0
    v_cvt_pk_bf16_f32 v8, v12, v13
    v_cvt_pk_bf16_f32 v9, v14, v15
    v_lshlrev_b32 v12, 16, v8
    v_and_b32 v13, 0xffff0000, v8
    v_lshlrev_b32 v14, 16, v9
    v_and_b32 v15, 0xffff0000, v9
    ds_write_b128 v3, v[12:15] offset:9216
    s_waitcnt lgkmcnt(0)
L_pubdone:
    s_mov_b64 exec, -1
    s_setprio 0
L_wait_g:
    s_waitcnt vmcnt(0) lgkmcnt(0)
    s_barrier
    ds_read_b128 v[24:27], v6
    ds_read_b128 v[28:31], v6 offset:16
    ds_read_b128 v[32:35], v7
    ds_read_b128 v[36:39], v7 offset:16
    ds_read_b128 v[40:43], v6 offset:256
    ds_read_b128 v[44:47], v6 offset:272
    s_mov_b32 s34, 0xffff0000
    s_add_u32 s32, s33, 12582912
    v_lshlrev_b32 v8, 16, v88
    v_and_b32 v9, s34, v88
    v_lshlrev_b32 v10, 16, v89
    v_and_b32 v11, s34, v89
    v_lshlrev_b32 v12, 16, v90
    v_and_b32 v13, s34, v90
    v_lshlrev_b32 v14, 16, v91
    v_and_b32 v15, s34, v91
    v_lshlrev_b32 v16, 16, v92
    v_and_b32 v17, s34, v92
    v_lshlrev_b32 v18, 16, v93
    v_and_b32 v19, s34, v93
    v_lshlrev_b32 v20, 16, v94
    v_and_b32 v21, s34, v94
    v_lshlrev_b32 v22, 16, v95
    v_and_b32 v23, s34, v95
    s_waitcnt lgkmcnt(4)
    v_pk_mul_f32 v[8:9], v[8:9], v[24:25]
    v_pk_mul_f32 v[10:11], v[10:11], v[26:27]
    v_pk_mul_f32 v[12:13], v[12:13], v[28:29]
    v_pk_mul_f32 v[14:15], v[14:15], v[30:31]
    v_cvt_pk_bf16_f32 v88, v8, v9
    v_cvt_pk_bf16_f32 v89, v10, v11
    v_cvt_pk_bf16_f32 v90, v12, v13
    v_cvt_pk_bf16_f32 v91, v14, v15
    buffer_store_dwordx4 v[88:91], v1, s[20:23], s32 offen offset:0 sc0 sc1
    s_waitcnt lgkmcnt(2)
    v_pk_mul_f32 v[16:17], v[16:17], v[32:33]
    v_pk_mul_f32 v[18:19], v[18:19], v[34:35]
    v_pk_mul_f32 v[20:21], v[20:21], v[36:37]
    v_pk_mul_f32 v[22:23], v[22:23], v[38:39]
    v_cvt_pk_bf16_f32 v92, v16, v17
    v_cvt_pk_bf16_f32 v93, v18, v19
    v_cvt_pk_bf16_f32 v94, v20, v21
    v_cvt_pk_bf16_f32 v95, v22, v23
    buffer_store_dwordx4 v[92:95], v1, s[20:23], s32 offen offset:256 sc0 sc1
    v_lshlrev_b32 v8, 16, v96
    v_and_b32 v9, s34, v96
    v_lshlrev_b32 v10, 16, v97
    v_and_b32 v11, s34, v97
    v_lshlrev_b32 v12, 16, v98
    v_and_b32 v13, s34, v98
    v_lshlrev_b32 v14, 16, v99
    v_and_b32 v15, s34, v99
    s_waitcnt lgkmcnt(0)
    v_pk_mul_f32 v[8:9], v[8:9], v[40:41]
    v_pk_mul_f32 v[10:11], v[10:11], v[42:43]
    v_pk_mul_f32 v[12:13], v[12:13], v[44:45]
    v_pk_mul_f32 v[14:15], v[14:15], v[46:47]
    v_cvt_pk_bf16_f32 v96, v8, v9
    v_cvt_pk_bf16_f32 v97, v10, v11
    v_cvt_pk_bf16_f32 v98, v12, v13
    v_cvt_pk_bf16_f32 v99, v14, v15
    buffer_store_dwordx4 v[96:99], v1, s[20:23], s32 offen offset:512 sc0 sc1
    s_add_u32 s32, s33, 18874368
    v_lshlrev_b32 v16, 16, v100
    v_and_b32 v17, s34, v100
    v_lshlrev_b32 v18, 16, v101
    v_and_b32 v19, s34, v101
    v_lshlrev_b32 v20, 16, v102
    v_and_b32 v21, s34, v102
    v_lshlrev_b32 v22, 16, v103
    v_and_b32 v23, s34, v103
    v_pk_mul_f32 v[16:17], v[16:17], v[24:25]
    v_pk_mul_f32 v[18:19], v[18:19], v[26:27]
    v_pk_mul_f32 v[20:21], v[20:21], v[28:29]
    v_pk_mul_f32 v[22:23], v[22:23], v[30:31]
    v_cvt_pk_bf16_f32 v100, v16, v17
    v_cvt_pk_bf16_f32 v101, v18, v19
    v_cvt_pk_bf16_f32 v102, v20, v21
    v_cvt_pk_bf16_f32 v103, v22, v23
    buffer_store_dwordx4 v[100:103], v1, s[20:23], s32 offen offset:0 sc0 sc1
    v_lshlrev_b32 v8, 16, v104
    v_and_b32 v9, s34, v104
    v_lshlrev_b32 v10, 16, v105
    v_and_b32 v11, s34, v105
    v_lshlrev_b32 v12, 16, v106
    v_and_b32 v13, s34, v106
    v_lshlrev_b32 v14, 16, v107
    v_and_b32 v15, s34, v107
    v_pk_mul_f32 v[8:9], v[8:9], v[32:33]
    v_pk_mul_f32 v[10:11], v[10:11], v[34:35]
    v_pk_mul_f32 v[12:13], v[12:13], v[36:37]
    v_pk_mul_f32 v[14:15], v[14:15], v[38:39]
    v_cvt_pk_bf16_f32 v104, v8, v9
    v_cvt_pk_bf16_f32 v105, v10, v11
    v_cvt_pk_bf16_f32 v106, v12, v13
    v_cvt_pk_bf16_f32 v107, v14, v15
    buffer_store_dwordx4 v[104:107], v1, s[20:23], s32 offen offset:256 sc0 sc1
    v_lshlrev_b32 v16, 16, v108
    v_and_b32 v17, s34, v108
    v_lshlrev_b32 v18, 16, v109
    v_and_b32 v19, s34, v109
    v_lshlrev_b32 v20, 16, v110
    v_and_b32 v21, s34, v110
    v_lshlrev_b32 v22, 16, v111
    v_and_b32 v23, s34, v111
    v_pk_mul_f32 v[16:17], v[16:17], v[40:41]
    v_pk_mul_f32 v[18:19], v[18:19], v[42:43]
    v_pk_mul_f32 v[20:21], v[20:21], v[44:45]
    v_pk_mul_f32 v[22:23], v[22:23], v[46:47]
    v_cvt_pk_bf16_f32 v108, v16, v17
    v_cvt_pk_bf16_f32 v109, v18, v19
    v_cvt_pk_bf16_f32 v110, v20, v21
    v_cvt_pk_bf16_f32 v111, v22, v23
    buffer_store_dwordx4 v[108:111], v1, s[20:23], s32 offen offset:512 sc0 sc1
    s_add_u32 s32, s33, 25165824
    v_lshlrev_b32 v8, 16, v112
    v_and_b32 v9, s34, v112
    v_lshlrev_b32 v10, 16, v113
    v_and_b32 v11, s34, v113
    v_lshlrev_b32 v12, 16, v114
    v_and_b32 v13, s34, v114
    v_lshlrev_b32 v14, 16, v115
    v_and_b32 v15, s34, v115
    v_pk_mul_f32 v[8:9], v[8:9], v[24:25]
    v_pk_mul_f32 v[10:11], v[10:11], v[26:27]
    v_pk_mul_f32 v[12:13], v[12:13], v[28:29]
    v_pk_mul_f32 v[14:15], v[14:15], v[30:31]
    v_cvt_pk_bf16_f32 v112, v8, v9
    v_cvt_pk_bf16_f32 v113, v10, v11
    v_cvt_pk_bf16_f32 v114, v12, v13
    v_cvt_pk_bf16_f32 v115, v14, v15
    buffer_store_dwordx4 v[112:115], v1, s[20:23], s32 offen offset:0 sc0 sc1
    v_lshlrev_b32 v16, 16, v116
    v_and_b32 v17, s34, v116
    v_lshlrev_b32 v18, 16, v117
    v_and_b32 v19, s34, v117
    v_lshlrev_b32 v20, 16, v118
    v_and_b32 v21, s34, v118
    v_lshlrev_b32 v22, 16, v119
    v_and_b32 v23, s34, v119
    v_pk_mul_f32 v[16:17], v[16:17], v[32:33]
    v_pk_mul_f32 v[18:19], v[18:19], v[34:35]
    v_pk_mul_f32 v[20:21], v[20:21], v[36:37]
    v_pk_mul_f32 v[22:23], v[22:23], v[38:39]
    v_cvt_pk_bf16_f32 v116, v16, v17
    v_cvt_pk_bf16_f32 v117, v18, v19
    v_cvt_pk_bf16_f32 v118, v20, v21
    v_cvt_pk_bf16_f32 v119, v22, v23
    buffer_store_dwordx4 v[116:119], v1, s[20:23], s32 offen offset:256 sc0 sc1
    v_lshlrev_b32 v8, 16, v120
    v_and_b32 v9, s34, v120
    v_lshlrev_b32 v10, 16, v121
    v_and_b32 v11, s34, v121
    v_lshlrev_b32 v12, 16, v122
    v_and_b32 v13, s34, v122
    v_lshlrev_b32 v14, 16, v123
    v_and_b32 v15, s34, v123
    v_pk_mul_f32 v[8:9], v[8:9], v[40:41]
    v_pk_mul_f32 v[10:11], v[10:11], v[42:43]
    v_pk_mul_f32 v[12:13], v[12:13], v[44:45]
    v_pk_mul_f32 v[14:15], v[14:15], v[46:47]
    v_cvt_pk_bf16_f32 v120, v8, v9
    v_cvt_pk_bf16_f32 v121, v10, v11
    v_cvt_pk_bf16_f32 v122, v12, v13
    v_cvt_pk_bf16_f32 v123, v14, v15
    buffer_store_dwordx4 v[120:123], v1, s[20:23], s32 offen offset:512 sc0 sc1
    s_add_u32 s32, s33, 31457280
    v_lshlrev_b32 v16, 16, v124
    v_and_b32 v17, s34, v124
    v_lshlrev_b32 v18, 16, v125
    v_and_b32 v19, s34, v125
    v_lshlrev_b32 v20, 16, v126
    v_and_b32 v21, s34, v126
    v_lshlrev_b32 v22, 16, v127
    v_and_b32 v23, s34, v127
    v_pk_mul_f32 v[16:17], v[16:17], v[24:25]
    v_pk_mul_f32 v[18:19], v[18:19], v[26:27]
    v_pk_mul_f32 v[20:21], v[20:21], v[28:29]
    v_pk_mul_f32 v[22:23], v[22:23], v[30:31]
    v_cvt_pk_bf16_f32 v124, v16, v17
    v_cvt_pk_bf16_f32 v125, v18, v19
    v_cvt_pk_bf16_f32 v126, v20, v21
    v_cvt_pk_bf16_f32 v127, v22, v23
    buffer_store_dwordx4 v[124:127], v1, s[20:23], s32 offen offset:0 sc0 sc1
    v_lshlrev_b32 v8, 16, v128
    v_and_b32 v9, s34, v128
    v_lshlrev_b32 v10, 16, v129
    v_and_b32 v11, s34, v129
    v_lshlrev_b32 v12, 16, v130
    v_and_b32 v13, s34, v130
    v_lshlrev_b32 v14, 16, v131
    v_and_b32 v15, s34, v131
    v_pk_mul_f32 v[8:9], v[8:9], v[32:33]
    v_pk_mul_f32 v[10:11], v[10:11], v[34:35]
    v_pk_mul_f32 v[12:13], v[12:13], v[36:37]
    v_pk_mul_f32 v[14:15], v[14:15], v[38:39]
    v_cvt_pk_bf16_f32 v128, v8, v9
    v_cvt_pk_bf16_f32 v129, v10, v11
    v_cvt_pk_bf16_f32 v130, v12, v13
    v_cvt_pk_bf16_f32 v131, v14, v15
    buffer_store_dwordx4 v[128:131], v1, s[20:23], s32 offen offset:256 sc0 sc1
    v_lshlrev_b32 v16, 16, v132
    v_and_b32 v17, s34, v132
    v_lshlrev_b32 v18, 16, v133
    v_and_b32 v19, s34, v133
    v_lshlrev_b32 v20, 16, v134
    v_and_b32 v21, s34, v134
    v_lshlrev_b32 v22, 16, v135
    v_and_b32 v23, s34, v135
    v_pk_mul_f32 v[16:17], v[16:17], v[40:41]
    v_pk_mul_f32 v[18:19], v[18:19], v[42:43]
    v_pk_mul_f32 v[20:21], v[20:21], v[44:45]
    v_pk_mul_f32 v[22:23], v[22:23], v[46:47]
    v_cvt_pk_bf16_f32 v132, v16, v17
    v_cvt_pk_bf16_f32 v133, v18, v19
    v_cvt_pk_bf16_f32 v134, v20, v21
    v_cvt_pk_bf16_f32 v135, v22, v23
    buffer_store_dwordx4 v[132:135], v1, s[20:23], s32 offen offset:512 sc0 sc1
    s_add_u32 s32, s33, 37748736
    v_lshlrev_b32 v8, 16, v136
    v_and_b32 v9, s34, v136
    v_lshlrev_b32 v10, 16, v137
    v_and_b32 v11, s34, v137
    v_lshlrev_b32 v12, 16, v138
    v_and_b32 v13, s34, v138
    v_lshlrev_b32 v14, 16, v139
    v_and_b32 v15, s34, v139
    v_pk_mul_f32 v[8:9], v[8:9], v[24:25]
    v_pk_mul_f32 v[10:11], v[10:11], v[26:27]
    v_pk_mul_f32 v[12:13], v[12:13], v[28:29]
    v_pk_mul_f32 v[14:15], v[14:15], v[30:31]
    v_cvt_pk_bf16_f32 v136, v8, v9
    v_cvt_pk_bf16_f32 v137, v10, v11
    v_cvt_pk_bf16_f32 v138, v12, v13
    v_cvt_pk_bf16_f32 v139, v14, v15
    buffer_store_dwordx4 v[136:139], v1, s[20:23], s32 offen offset:0 sc0 sc1
    v_lshlrev_b32 v16, 16, v140
    v_and_b32 v17, s34, v140
    v_lshlrev_b32 v18, 16, v141
    v_and_b32 v19, s34, v141
    v_lshlrev_b32 v20, 16, v142
    v_and_b32 v21, s34, v142
    v_lshlrev_b32 v22, 16, v143
    v_and_b32 v23, s34, v143
    v_pk_mul_f32 v[16:17], v[16:17], v[32:33]
    v_pk_mul_f32 v[18:19], v[18:19], v[34:35]
    v_pk_mul_f32 v[20:21], v[20:21], v[36:37]
    v_pk_mul_f32 v[22:23], v[22:23], v[38:39]
    v_cvt_pk_bf16_f32 v140, v16, v17
    v_cvt_pk_bf16_f32 v141, v18, v19
    v_cvt_pk_bf16_f32 v142, v20, v21
    v_cvt_pk_bf16_f32 v143, v22, v23
    buffer_store_dwordx4 v[140:143], v1, s[20:23], s32 offen offset:256 sc0 sc1
    v_lshlrev_b32 v8, 16, v144
    v_and_b32 v9, s34, v144
    v_lshlrev_b32 v10, 16, v145
    v_and_b32 v11, s34, v145
    v_lshlrev_b32 v12, 16, v146
    v_and_b32 v13, s34, v146
    v_lshlrev_b32 v14, 16, v147
    v_and_b32 v15, s34, v147
    v_pk_mul_f32 v[8:9], v[8:9], v[40:41]
    v_pk_mul_f32 v[10:11], v[10:11], v[42:43]
    v_pk_mul_f32 v[12:13], v[12:13], v[44:45]
    v_pk_mul_f32 v[14:15], v[14:15], v[46:47]
    v_cvt_pk_bf16_f32 v144, v8, v9
    v_cvt_pk_bf16_f32 v145, v10, v11
    v_cvt_pk_bf16_f32 v146, v12, v13
    v_cvt_pk_bf16_f32 v147, v14, v15
    buffer_store_dwordx4 v[144:147], v1, s[20:23], s32 offen offset:512 sc0 sc1
    s_add_u32 s32, s33, 44040192
    v_lshlrev_b32 v16, 16, v148
    v_and_b32 v17, s34, v148
    v_lshlrev_b32 v18, 16, v149
    v_and_b32 v19, s34, v149
    v_lshlrev_b32 v20, 16, v150
    v_and_b32 v21, s34, v150
    v_lshlrev_b32 v22, 16, v151
    v_and_b32 v23, s34, v151
    v_pk_mul_f32 v[16:17], v[16:17], v[24:25]
    v_pk_mul_f32 v[18:19], v[18:19], v[26:27]
    v_pk_mul_f32 v[20:21], v[20:21], v[28:29]
    v_pk_mul_f32 v[22:23], v[22:23], v[30:31]
    v_cvt_pk_bf16_f32 v148, v16, v17
    v_cvt_pk_bf16_f32 v149, v18, v19
    v_cvt_pk_bf16_f32 v150, v20, v21
    v_cvt_pk_bf16_f32 v151, v22, v23
    buffer_store_dwordx4 v[148:151], v1, s[20:23], s32 offen offset:0 sc0 sc1
    v_lshlrev_b32 v8, 16, v152
    v_and_b32 v9, s34, v152
    v_lshlrev_b32 v10, 16, v153
    v_and_b32 v11, s34, v153
    v_lshlrev_b32 v12, 16, v154
    v_and_b32 v13, s34, v154
    v_lshlrev_b32 v14, 16, v155
    v_and_b32 v15, s34, v155
    v_pk_mul_f32 v[8:9], v[8:9], v[32:33]
    v_pk_mul_f32 v[10:11], v[10:11], v[34:35]
    v_pk_mul_f32 v[12:13], v[12:13], v[36:37]
    v_pk_mul_f32 v[14:15], v[14:15], v[38:39]
    v_cvt_pk_bf16_f32 v152, v8, v9
    v_cvt_pk_bf16_f32 v153, v10, v11
    v_cvt_pk_bf16_f32 v154, v12, v13
    v_cvt_pk_bf16_f32 v155, v14, v15
    buffer_store_dwordx4 v[152:155], v1, s[20:23], s32 offen offset:256 sc0 sc1
    v_lshlrev_b32 v16, 16, v156
    v_and_b32 v17, s34, v156
    v_lshlrev_b32 v18, 16, v157
    v_and_b32 v19, s34, v157
    v_lshlrev_b32 v20, 16, v158
    v_and_b32 v21, s34, v158
    v_lshlrev_b32 v22, 16, v159
    v_and_b32 v23, s34, v159
    v_pk_mul_f32 v[16:17], v[16:17], v[40:41]
    v_pk_mul_f32 v[18:19], v[18:19], v[42:43]
    v_pk_mul_f32 v[20:21], v[20:21], v[44:45]
    v_pk_mul_f32 v[22:23], v[22:23], v[46:47]
    v_cvt_pk_bf16_f32 v156, v16, v17
    v_cvt_pk_bf16_f32 v157, v18, v19
    v_cvt_pk_bf16_f32 v158, v20, v21
    v_cvt_pk_bf16_f32 v159, v22, v23
    buffer_store_dwordx4 v[156:159], v1, s[20:23], s32 offen offset:512 sc0 sc1
    s_add_u32 s32, s33, 50331648
    v_lshlrev_b32 v8, 16, v160
    v_and_b32 v9, s34, v160
    v_lshlrev_b32 v10, 16, v161
    v_and_b32 v11, s34, v161
    v_lshlrev_b32 v12, 16, v162
    v_and_b32 v13, s34, v162
    v_lshlrev_b32 v14, 16, v163
    v_and_b32 v15, s34, v163
    v_pk_mul_f32 v[8:9], v[8:9], v[24:25]
    v_pk_mul_f32 v[10:11], v[10:11], v[26:27]
    v_pk_mul_f32 v[12:13], v[12:13], v[28:29]
    v_pk_mul_f32 v[14:15], v[14:15], v[30:31]
    v_cvt_pk_bf16_f32 v160, v8, v9
    v_cvt_pk_bf16_f32 v161, v10, v11
    v_cvt_pk_bf16_f32 v162, v12, v13
    v_cvt_pk_bf16_f32 v163, v14, v15
    buffer_store_dwordx4 v[160:163], v1, s[20:23], s32 offen offset:0 sc0 sc1
    v_lshlrev_b32 v16, 16, v164
    v_and_b32 v17, s34, v164
    v_lshlrev_b32 v18, 16, v165
    v_and_b32 v19, s34, v165
    v_lshlrev_b32 v20, 16, v166
    v_and_b32 v21, s34, v166
    v_lshlrev_b32 v22, 16, v167
    v_and_b32 v23, s34, v167
    v_pk_mul_f32 v[16:17], v[16:17], v[32:33]
    v_pk_mul_f32 v[18:19], v[18:19], v[34:35]
    v_pk_mul_f32 v[20:21], v[20:21], v[36:37]
    v_pk_mul_f32 v[22:23], v[22:23], v[38:39]
    v_cvt_pk_bf16_f32 v164, v16, v17
    v_cvt_pk_bf16_f32 v165, v18, v19
    v_cvt_pk_bf16_f32 v166, v20, v21
    v_cvt_pk_bf16_f32 v167, v22, v23
    buffer_store_dwordx4 v[164:167], v1, s[20:23], s32 offen offset:256 sc0 sc1
    v_lshlrev_b32 v8, 16, v168
    v_and_b32 v9, s34, v168
    v_lshlrev_b32 v10, 16, v169
    v_and_b32 v11, s34, v169
    v_lshlrev_b32 v12, 16, v170
    v_and_b32 v13, s34, v170
    v_lshlrev_b32 v14, 16, v171
    v_and_b32 v15, s34, v171
    v_pk_mul_f32 v[8:9], v[8:9], v[40:41]
    v_pk_mul_f32 v[10:11], v[10:11], v[42:43]
    v_pk_mul_f32 v[12:13], v[12:13], v[44:45]
    v_pk_mul_f32 v[14:15], v[14:15], v[46:47]
    v_cvt_pk_bf16_f32 v168, v8, v9
    v_cvt_pk_bf16_f32 v169, v10, v11
    v_cvt_pk_bf16_f32 v170, v12, v13
    v_cvt_pk_bf16_f32 v171, v14, v15
    buffer_store_dwordx4 v[168:171], v1, s[20:23], s32 offen offset:512 sc0 sc1
    s_add_u32 s32, s33, 56623104
    v_lshlrev_b32 v16, 16, v172
    v_and_b32 v17, s34, v172
    v_lshlrev_b32 v18, 16, v173
    v_and_b32 v19, s34, v173
    v_lshlrev_b32 v20, 16, v174
    v_and_b32 v21, s34, v174
    v_lshlrev_b32 v22, 16, v175
    v_and_b32 v23, s34, v175
    v_pk_mul_f32 v[16:17], v[16:17], v[24:25]
    v_pk_mul_f32 v[18:19], v[18:19], v[26:27]
    v_pk_mul_f32 v[20:21], v[20:21], v[28:29]
    v_pk_mul_f32 v[22:23], v[22:23], v[30:31]
    v_cvt_pk_bf16_f32 v172, v16, v17
    v_cvt_pk_bf16_f32 v173, v18, v19
    v_cvt_pk_bf16_f32 v174, v20, v21
    v_cvt_pk_bf16_f32 v175, v22, v23
    buffer_store_dwordx4 v[172:175], v1, s[20:23], s32 offen offset:0 sc0 sc1
    v_lshlrev_b32 v8, 16, v176
    v_and_b32 v9, s34, v176
    v_lshlrev_b32 v10, 16, v177
    v_and_b32 v11, s34, v177
    v_lshlrev_b32 v12, 16, v178
    v_and_b32 v13, s34, v178
    v_lshlrev_b32 v14, 16, v179
    v_and_b32 v15, s34, v179
    v_pk_mul_f32 v[8:9], v[8:9], v[32:33]
    v_pk_mul_f32 v[10:11], v[10:11], v[34:35]
    v_pk_mul_f32 v[12:13], v[12:13], v[36:37]
    v_pk_mul_f32 v[14:15], v[14:15], v[38:39]
    v_cvt_pk_bf16_f32 v176, v8, v9
    v_cvt_pk_bf16_f32 v177, v10, v11
    v_cvt_pk_bf16_f32 v178, v12, v13
    v_cvt_pk_bf16_f32 v179, v14, v15
    buffer_store_dwordx4 v[176:179], v1, s[20:23], s32 offen offset:256 sc0 sc1
    v_lshlrev_b32 v16, 16, v180
    v_and_b32 v17, s34, v180
    v_lshlrev_b32 v18, 16, v181
    v_and_b32 v19, s34, v181
    v_lshlrev_b32 v20, 16, v182
    v_and_b32 v21, s34, v182
    v_lshlrev_b32 v22, 16, v183
    v_and_b32 v23, s34, v183
    v_pk_mul_f32 v[16:17], v[16:17], v[40:41]
    v_pk_mul_f32 v[18:19], v[18:19], v[42:43]
    v_pk_mul_f32 v[20:21], v[20:21], v[44:45]
    v_pk_mul_f32 v[22:23], v[22:23], v[46:47]
    v_cvt_pk_bf16_f32 v180, v16, v17
    v_cvt_pk_bf16_f32 v181, v18, v19
    v_cvt_pk_bf16_f32 v182, v20, v21
    v_cvt_pk_bf16_f32 v183, v22, v23
    buffer_store_dwordx4 v[180:183], v1, s[20:23], s32 offen offset:512 sc0 sc1
    s_add_u32 s32, s33, 62914560
    v_lshlrev_b32 v8, 16, v184
    v_and_b32 v9, s34, v184
    v_lshlrev_b32 v10, 16, v185
    v_and_b32 v11, s34, v185
    v_lshlrev_b32 v12, 16, v186
    v_and_b32 v13, s34, v186
    v_lshlrev_b32 v14, 16, v187
    v_and_b32 v15, s34, v187
    v_pk_mul_f32 v[8:9], v[8:9], v[24:25]
    v_pk_mul_f32 v[10:11], v[10:11], v[26:27]
    v_pk_mul_f32 v[12:13], v[12:13], v[28:29]
    v_pk_mul_f32 v[14:15], v[14:15], v[30:31]
    v_cvt_pk_bf16_f32 v184, v8, v9
    v_cvt_pk_bf16_f32 v185, v10, v11
    v_cvt_pk_bf16_f32 v186, v12, v13
    v_cvt_pk_bf16_f32 v187, v14, v15
    buffer_store_dwordx4 v[184:187], v1, s[20:23], s32 offen offset:0 sc0 sc1
    v_lshlrev_b32 v16, 16, v188
    v_and_b32 v17, s34, v188
    v_lshlrev_b32 v18, 16, v189
    v_and_b32 v19, s34, v189
    v_lshlrev_b32 v20, 16, v190
    v_and_b32 v21, s34, v190
    v_lshlrev_b32 v22, 16, v191
    v_and_b32 v23, s34, v191
    v_pk_mul_f32 v[16:17], v[16:17], v[32:33]
    v_pk_mul_f32 v[18:19], v[18:19], v[34:35]
    v_pk_mul_f32 v[20:21], v[20:21], v[36:37]
    v_pk_mul_f32 v[22:23], v[22:23], v[38:39]
    v_cvt_pk_bf16_f32 v188, v16, v17
    v_cvt_pk_bf16_f32 v189, v18, v19
    v_cvt_pk_bf16_f32 v190, v20, v21
    v_cvt_pk_bf16_f32 v191, v22, v23
    buffer_store_dwordx4 v[188:191], v1, s[20:23], s32 offen offset:256 sc0 sc1
    v_lshlrev_b32 v8, 16, v192
    v_and_b32 v9, s34, v192
    v_lshlrev_b32 v10, 16, v193
    v_and_b32 v11, s34, v193
    v_lshlrev_b32 v12, 16, v194
    v_and_b32 v13, s34, v194
    v_lshlrev_b32 v14, 16, v195
    v_and_b32 v15, s34, v195
    v_pk_mul_f32 v[8:9], v[8:9], v[40:41]
    v_pk_mul_f32 v[10:11], v[10:11], v[42:43]
    v_pk_mul_f32 v[12:13], v[12:13], v[44:45]
    v_pk_mul_f32 v[14:15], v[14:15], v[46:47]
    v_cvt_pk_bf16_f32 v192, v8, v9
    v_cvt_pk_bf16_f32 v193, v10, v11
    v_cvt_pk_bf16_f32 v194, v12, v13
    v_cvt_pk_bf16_f32 v195, v14, v15
    buffer_store_dwordx4 v[192:195], v1, s[20:23], s32 offen offset:512 sc0 sc1
    s_add_u32 s32, s33, 69206016
    v_lshlrev_b32 v16, 16, v196
    v_and_b32 v17, s34, v196
    v_lshlrev_b32 v18, 16, v197
    v_and_b32 v19, s34, v197
    v_lshlrev_b32 v20, 16, v198
    v_and_b32 v21, s34, v198
    v_lshlrev_b32 v22, 16, v199
    v_and_b32 v23, s34, v199
    v_pk_mul_f32 v[16:17], v[16:17], v[24:25]
    v_pk_mul_f32 v[18:19], v[18:19], v[26:27]
    v_pk_mul_f32 v[20:21], v[20:21], v[28:29]
    v_pk_mul_f32 v[22:23], v[22:23], v[30:31]
    v_cvt_pk_bf16_f32 v196, v16, v17
    v_cvt_pk_bf16_f32 v197, v18, v19
    v_cvt_pk_bf16_f32 v198, v20, v21
    v_cvt_pk_bf16_f32 v199, v22, v23
    buffer_store_dwordx4 v[196:199], v1, s[20:23], s32 offen offset:0 sc0 sc1
    v_lshlrev_b32 v8, 16, v200
    v_and_b32 v9, s34, v200
    v_lshlrev_b32 v10, 16, v201
    v_and_b32 v11, s34, v201
    v_lshlrev_b32 v12, 16, v202
    v_and_b32 v13, s34, v202
    v_lshlrev_b32 v14, 16, v203
    v_and_b32 v15, s34, v203
    v_pk_mul_f32 v[8:9], v[8:9], v[32:33]
    v_pk_mul_f32 v[10:11], v[10:11], v[34:35]
    v_pk_mul_f32 v[12:13], v[12:13], v[36:37]
    v_pk_mul_f32 v[14:15], v[14:15], v[38:39]
    v_cvt_pk_bf16_f32 v200, v8, v9
    v_cvt_pk_bf16_f32 v201, v10, v11
    v_cvt_pk_bf16_f32 v202, v12, v13
    v_cvt_pk_bf16_f32 v203, v14, v15
    buffer_store_dwordx4 v[200:203], v1, s[20:23], s32 offen offset:256 sc0 sc1
    v_lshlrev_b32 v16, 16, v204
    v_and_b32 v17, s34, v204
    v_lshlrev_b32 v18, 16, v205
    v_and_b32 v19, s34, v205
    v_lshlrev_b32 v20, 16, v206
    v_and_b32 v21, s34, v206
    v_lshlrev_b32 v22, 16, v207
    v_and_b32 v23, s34, v207
    v_pk_mul_f32 v[16:17], v[16:17], v[40:41]
    v_pk_mul_f32 v[18:19], v[18:19], v[42:43]
    v_pk_mul_f32 v[20:21], v[20:21], v[44:45]
    v_pk_mul_f32 v[22:23], v[22:23], v[46:47]
    v_cvt_pk_bf16_f32 v204, v16, v17
    v_cvt_pk_bf16_f32 v205, v18, v19
    v_cvt_pk_bf16_f32 v206, v20, v21
    v_cvt_pk_bf16_f32 v207, v22, v23
    buffer_store_dwordx4 v[204:207], v1, s[20:23], s32 offen offset:512 sc0 sc1
    s_add_u32 s32, s33, 75497472
    v_lshlrev_b32 v8, 16, v208
    v_and_b32 v9, s34, v208
    v_lshlrev_b32 v10, 16, v209
    v_and_b32 v11, s34, v209
    v_lshlrev_b32 v12, 16, v210
    v_and_b32 v13, s34, v210
    v_lshlrev_b32 v14, 16, v211
    v_and_b32 v15, s34, v211
    v_pk_mul_f32 v[8:9], v[8:9], v[24:25]
    v_pk_mul_f32 v[10:11], v[10:11], v[26:27]
    v_pk_mul_f32 v[12:13], v[12:13], v[28:29]
    v_pk_mul_f32 v[14:15], v[14:15], v[30:31]
    v_cvt_pk_bf16_f32 v208, v8, v9
    v_cvt_pk_bf16_f32 v209, v10, v11
    v_cvt_pk_bf16_f32 v210, v12, v13
    v_cvt_pk_bf16_f32 v211, v14, v15
    buffer_store_dwordx4 v[208:211], v1, s[20:23], s32 offen offset:0 sc0 sc1
    v_lshlrev_b32 v16, 16, v212
    v_and_b32 v17, s34, v212
    v_lshlrev_b32 v18, 16, v213
    v_and_b32 v19, s34, v213
    v_lshlrev_b32 v20, 16, v214
    v_and_b32 v21, s34, v214
    v_lshlrev_b32 v22, 16, v215
    v_and_b32 v23, s34, v215
    v_pk_mul_f32 v[16:17], v[16:17], v[32:33]
    v_pk_mul_f32 v[18:19], v[18:19], v[34:35]
    v_pk_mul_f32 v[20:21], v[20:21], v[36:37]
    v_pk_mul_f32 v[22:23], v[22:23], v[38:39]
    v_cvt_pk_bf16_f32 v212, v16, v17
    v_cvt_pk_bf16_f32 v213, v18, v19
    v_cvt_pk_bf16_f32 v214, v20, v21
    v_cvt_pk_bf16_f32 v215, v22, v23
    buffer_store_dwordx4 v[212:215], v1, s[20:23], s32 offen offset:256 sc0 sc1
    v_lshlrev_b32 v8, 16, v216
    v_and_b32 v9, s34, v216
    v_lshlrev_b32 v10, 16, v217
    v_and_b32 v11, s34, v217
    v_lshlrev_b32 v12, 16, v218
    v_and_b32 v13, s34, v218
    v_lshlrev_b32 v14, 16, v219
    v_and_b32 v15, s34, v219
    v_pk_mul_f32 v[8:9], v[8:9], v[40:41]
    v_pk_mul_f32 v[10:11], v[10:11], v[42:43]
    v_pk_mul_f32 v[12:13], v[12:13], v[44:45]
    v_pk_mul_f32 v[14:15], v[14:15], v[46:47]
    v_cvt_pk_bf16_f32 v216, v8, v9
    v_cvt_pk_bf16_f32 v217, v10, v11
    v_cvt_pk_bf16_f32 v218, v12, v13
    v_cvt_pk_bf16_f32 v219, v14, v15
    buffer_store_dwordx4 v[216:219], v1, s[20:23], s32 offen offset:512 sc0 sc1
    s_add_u32 s32, s33, 81788928
    v_lshlrev_b32 v16, 16, v220
    v_and_b32 v17, s34, v220
    v_lshlrev_b32 v18, 16, v221
    v_and_b32 v19, s34, v221
    v_lshlrev_b32 v20, 16, v222
    v_and_b32 v21, s34, v222
    v_lshlrev_b32 v22, 16, v223
    v_and_b32 v23, s34, v223
    v_pk_mul_f32 v[16:17], v[16:17], v[24:25]
    v_pk_mul_f32 v[18:19], v[18:19], v[26:27]
    v_pk_mul_f32 v[20:21], v[20:21], v[28:29]
    v_pk_mul_f32 v[22:23], v[22:23], v[30:31]
    v_cvt_pk_bf16_f32 v220, v16, v17
    v_cvt_pk_bf16_f32 v221, v18, v19
    v_cvt_pk_bf16_f32 v222, v20, v21
    v_cvt_pk_bf16_f32 v223, v22, v23
    buffer_store_dwordx4 v[220:223], v1, s[20:23], s32 offen offset:0 sc0 sc1
    v_lshlrev_b32 v8, 16, v224
    v_and_b32 v9, s34, v224
    v_lshlrev_b32 v10, 16, v225
    v_and_b32 v11, s34, v225
    v_lshlrev_b32 v12, 16, v226
    v_and_b32 v13, s34, v226
    v_lshlrev_b32 v14, 16, v227
    v_and_b32 v15, s34, v227
    v_pk_mul_f32 v[8:9], v[8:9], v[32:33]
    v_pk_mul_f32 v[10:11], v[10:11], v[34:35]
    v_pk_mul_f32 v[12:13], v[12:13], v[36:37]
    v_pk_mul_f32 v[14:15], v[14:15], v[38:39]
    v_cvt_pk_bf16_f32 v224, v8, v9
    v_cvt_pk_bf16_f32 v225, v10, v11
    v_cvt_pk_bf16_f32 v226, v12, v13
    v_cvt_pk_bf16_f32 v227, v14, v15
    buffer_store_dwordx4 v[224:227], v1, s[20:23], s32 offen offset:256 sc0 sc1
    v_lshlrev_b32 v16, 16, v228
    v_and_b32 v17, s34, v228
    v_lshlrev_b32 v18, 16, v229
    v_and_b32 v19, s34, v229
    v_lshlrev_b32 v20, 16, v230
    v_and_b32 v21, s34, v230
    v_lshlrev_b32 v22, 16, v231
    v_and_b32 v23, s34, v231
    v_pk_mul_f32 v[16:17], v[16:17], v[40:41]
    v_pk_mul_f32 v[18:19], v[18:19], v[42:43]
    v_pk_mul_f32 v[20:21], v[20:21], v[44:45]
    v_pk_mul_f32 v[22:23], v[22:23], v[46:47]
    v_cvt_pk_bf16_f32 v228, v16, v17
    v_cvt_pk_bf16_f32 v229, v18, v19
    v_cvt_pk_bf16_f32 v230, v20, v21
    v_cvt_pk_bf16_f32 v231, v22, v23
    buffer_store_dwordx4 v[228:231], v1, s[20:23], s32 offen offset:512 sc0 sc1
    s_add_u32 s32, s33, 0
    s_add_u32 s35, s37, 6291456
    s_bitcmp1_b32 s2, 0
    s_cselect_b32 s32, s32, s35
    v_lshlrev_b32 v8, 16, v64
    v_and_b32 v9, s34, v64
    v_lshlrev_b32 v10, 16, v65
    v_and_b32 v11, s34, v65
    v_lshlrev_b32 v12, 16, v66
    v_and_b32 v13, s34, v66
    v_lshlrev_b32 v14, 16, v67
    v_and_b32 v15, s34, v67
    v_pk_mul_f32 v[8:9], v[8:9], v[24:25]
    v_pk_mul_f32 v[10:11], v[10:11], v[26:27]
    v_pk_mul_f32 v[12:13], v[12:13], v[28:29]
    v_pk_mul_f32 v[14:15], v[14:15], v[30:31]
    v_cvt_pk_bf16_f32 v64, v8, v9
    v_cvt_pk_bf16_f32 v65, v10, v11
    v_cvt_pk_bf16_f32 v66, v12, v13
    v_cvt_pk_bf16_f32 v67, v14, v15
    buffer_store_dwordx4 v[64:67], v1, s[20:23], s32 offen offset:0 sc0 sc1
    v_lshlrev_b32 v16, 16, v68
    v_and_b32 v17, s34, v68
    v_lshlrev_b32 v18, 16, v69
    v_and_b32 v19, s34, v69
    v_lshlrev_b32 v20, 16, v70
    v_and_b32 v21, s34, v70
    v_lshlrev_b32 v22, 16, v71
    v_and_b32 v23, s34, v71
    v_pk_mul_f32 v[16:17], v[16:17], v[32:33]
    v_pk_mul_f32 v[18:19], v[18:19], v[34:35]
    v_pk_mul_f32 v[20:21], v[20:21], v[36:37]
    v_pk_mul_f32 v[22:23], v[22:23], v[38:39]
    v_cvt_pk_bf16_f32 v68, v16, v17
    v_cvt_pk_bf16_f32 v69, v18, v19
    v_cvt_pk_bf16_f32 v70, v20, v21
    v_cvt_pk_bf16_f32 v71, v22, v23
    buffer_store_dwordx4 v[68:71], v1, s[20:23], s32 offen offset:256 sc0 sc1
    v_lshlrev_b32 v8, 16, v72
    v_and_b32 v9, s34, v72
    v_lshlrev_b32 v10, 16, v73
    v_and_b32 v11, s34, v73
    v_lshlrev_b32 v12, 16, v74
    v_and_b32 v13, s34, v74
    v_lshlrev_b32 v14, 16, v75
    v_and_b32 v15, s34, v75
    v_pk_mul_f32 v[8:9], v[8:9], v[40:41]
    v_pk_mul_f32 v[10:11], v[10:11], v[42:43]
    v_pk_mul_f32 v[12:13], v[12:13], v[44:45]
    v_pk_mul_f32 v[14:15], v[14:15], v[46:47]
    v_cvt_pk_bf16_f32 v72, v8, v9
    v_cvt_pk_bf16_f32 v73, v10, v11
    v_cvt_pk_bf16_f32 v74, v12, v13
    v_cvt_pk_bf16_f32 v75, v14, v15
    buffer_store_dwordx4 v[72:75], v1, s[20:23], s32 offen offset:512 sc0 sc1
    s_add_u32 s32, s33, 6291456
    s_add_u32 s35, s37, 9437184
    s_bitcmp1_b32 s2, 0
    s_cselect_b32 s32, s32, s35
    v_lshlrev_b32 v16, 16, v76
    v_and_b32 v17, s34, v76
    v_lshlrev_b32 v18, 16, v77
    v_and_b32 v19, s34, v77
    v_lshlrev_b32 v20, 16, v78
    v_and_b32 v21, s34, v78
    v_lshlrev_b32 v22, 16, v79
    v_and_b32 v23, s34, v79
    v_pk_mul_f32 v[16:17], v[16:17], v[24:25]
    v_pk_mul_f32 v[18:19], v[18:19], v[26:27]
    v_pk_mul_f32 v[20:21], v[20:21], v[28:29]
    v_pk_mul_f32 v[22:23], v[22:23], v[30:31]
    v_cvt_pk_bf16_f32 v76, v16, v17
    v_cvt_pk_bf16_f32 v77, v18, v19
    v_cvt_pk_bf16_f32 v78, v20, v21
    v_cvt_pk_bf16_f32 v79, v22, v23
    buffer_store_dwordx4 v[76:79], v1, s[20:23], s32 offen offset:0 sc0 sc1
    v_lshlrev_b32 v8, 16, v80
    v_and_b32 v9, s34, v80
    v_lshlrev_b32 v10, 16, v81
    v_and_b32 v11, s34, v81
    v_lshlrev_b32 v12, 16, v82
    v_and_b32 v13, s34, v82
    v_lshlrev_b32 v14, 16, v83
    v_and_b32 v15, s34, v83
    v_pk_mul_f32 v[8:9], v[8:9], v[32:33]
    v_pk_mul_f32 v[10:11], v[10:11], v[34:35]
    v_pk_mul_f32 v[12:13], v[12:13], v[36:37]
    v_pk_mul_f32 v[14:15], v[14:15], v[38:39]
    v_cvt_pk_bf16_f32 v80, v8, v9
    v_cvt_pk_bf16_f32 v81, v10, v11
    v_cvt_pk_bf16_f32 v82, v12, v13
    v_cvt_pk_bf16_f32 v83, v14, v15
    buffer_store_dwordx4 v[80:83], v1, s[20:23], s32 offen offset:256 sc0 sc1
    v_lshlrev_b32 v16, 16, v84
    v_and_b32 v17, s34, v84
    v_lshlrev_b32 v18, 16, v85
    v_and_b32 v19, s34, v85
    v_lshlrev_b32 v20, 16, v86
    v_and_b32 v21, s34, v86
    v_lshlrev_b32 v22, 16, v87
    v_and_b32 v23, s34, v87
    v_pk_mul_f32 v[16:17], v[16:17], v[40:41]
    v_pk_mul_f32 v[18:19], v[18:19], v[42:43]
    v_pk_mul_f32 v[20:21], v[20:21], v[44:45]
    v_pk_mul_f32 v[22:23], v[22:23], v[46:47]
    v_cvt_pk_bf16_f32 v84, v16, v17
    v_cvt_pk_bf16_f32 v85, v18, v19
    v_cvt_pk_bf16_f32 v86, v20, v21
    v_cvt_pk_bf16_f32 v87, v22, v23
    buffer_store_dwordx4 v[84:87], v1, s[20:23], s32 offen offset:512 sc0 sc1
    s_bitcmp1_b32 s2, 0
    s_cbranch_scc1 L_st_done
    ds_read_b128 v[64:67], v0 offset:0
    ds_read_b128 v[68:71], v0 offset:1024
    ds_read_b128 v[72:75], v0 offset:2048
    ds_read_b128 v[76:79], v0 offset:3072
    ds_read_b128 v[80:83], v0 offset:4096
    ds_read_b128 v[84:87], v0 offset:5120
    s_add_u32 s32, s37, 0
    v_lshlrev_b32 v8, 16, v232
    v_and_b32 v9, s34, v232
    v_lshlrev_b32 v10, 16, v233
    v_and_b32 v11, s34, v233
    v_lshlrev_b32 v12, 16, v234
    v_and_b32 v13, s34, v234
    v_lshlrev_b32 v14, 16, v235
    v_and_b32 v15, s34, v235
    v_pk_mul_f32 v[8:9], v[8:9], v[24:25]
    v_pk_mul_f32 v[10:11], v[10:11], v[26:27]
    v_pk_mul_f32 v[12:13], v[12:13], v[28:29]
    v_pk_mul_f32 v[14:15], v[14:15], v[30:31]
    v_cvt_pk_bf16_f32 v232, v8, v9
    v_cvt_pk_bf16_f32 v233, v10, v11
    v_cvt_pk_bf16_f32 v234, v12, v13
    v_cvt_pk_bf16_f32 v235, v14, v15
    buffer_store_dwordx4 v[232:235], v1, s[20:23], s32 offen offset:0 sc0 sc1
    v_lshlrev_b32 v16, 16, v236
    v_and_b32 v17, s34, v236
    v_lshlrev_b32 v18, 16, v237
    v_and_b32 v19, s34, v237
    v_lshlrev_b32 v20, 16, v238
    v_and_b32 v21, s34, v238
    v_lshlrev_b32 v22, 16, v239
    v_and_b32 v23, s34, v239
    v_pk_mul_f32 v[16:17], v[16:17], v[32:33]
    v_pk_mul_f32 v[18:19], v[18:19], v[34:35]
    v_pk_mul_f32 v[20:21], v[20:21], v[36:37]
    v_pk_mul_f32 v[22:23], v[22:23], v[38:39]
    v_cvt_pk_bf16_f32 v236, v16, v17
    v_cvt_pk_bf16_f32 v237, v18, v19
    v_cvt_pk_bf16_f32 v238, v20, v21
    v_cvt_pk_bf16_f32 v239, v22, v23
    buffer_store_dwordx4 v[236:239], v1, s[20:23], s32 offen offset:256 sc0 sc1
    v_lshlrev_b32 v8, 16, v240
    v_and_b32 v9, s34, v240
    v_lshlrev_b32 v10, 16, v241
    v_and_b32 v11, s34, v241
    v_lshlrev_b32 v12, 16, v242
    v_and_b32 v13, s34, v242
    v_lshlrev_b32 v14, 16, v243
    v_and_b32 v15, s34, v243
    v_pk_mul_f32 v[8:9], v[8:9], v[40:41]
    v_pk_mul_f32 v[10:11], v[10:11], v[42:43]
    v_pk_mul_f32 v[12:13], v[12:13], v[44:45]
    v_pk_mul_f32 v[14:15], v[14:15], v[46:47]
    v_cvt_pk_bf16_f32 v240, v8, v9
    v_cvt_pk_bf16_f32 v241, v10, v11
    v_cvt_pk_bf16_f32 v242, v12, v13
    v_cvt_pk_bf16_f32 v243, v14, v15
    buffer_store_dwordx4 v[240:243], v1, s[20:23], s32 offen offset:512 sc0 sc1
    s_add_u32 s32, s37, 3145728
    v_lshlrev_b32 v16, 16, v244
    v_and_b32 v17, s34, v244
    v_lshlrev_b32 v18, 16, v245
    v_and_b32 v19, s34, v245
    v_lshlrev_b32 v20, 16, v246
    v_and_b32 v21, s34, v246
    v_lshlrev_b32 v22, 16, v247
    v_and_b32 v23, s34, v247
    v_pk_mul_f32 v[16:17], v[16:17], v[24:25]
    v_pk_mul_f32 v[18:19], v[18:19], v[26:27]
    v_pk_mul_f32 v[20:21], v[20:21], v[28:29]
    v_pk_mul_f32 v[22:23], v[22:23], v[30:31]
    v_cvt_pk_bf16_f32 v244, v16, v17
    v_cvt_pk_bf16_f32 v245, v18, v19
    v_cvt_pk_bf16_f32 v246, v20, v21
    v_cvt_pk_bf16_f32 v247, v22, v23
    buffer_store_dwordx4 v[244:247], v1, s[20:23], s32 offen offset:0 sc0 sc1
    v_lshlrev_b32 v8, 16, v248
    v_and_b32 v9, s34, v248
    v_lshlrev_b32 v10, 16, v249
    v_and_b32 v11, s34, v249
    v_lshlrev_b32 v12, 16, v250
    v_and_b32 v13, s34, v250
    v_lshlrev_b32 v14, 16, v251
    v_and_b32 v15, s34, v251
    v_pk_mul_f32 v[8:9], v[8:9], v[32:33]
    v_pk_mul_f32 v[10:11], v[10:11], v[34:35]
    v_pk_mul_f32 v[12:13], v[12:13], v[36:37]
    v_pk_mul_f32 v[14:15], v[14:15], v[38:39]
    v_cvt_pk_bf16_f32 v248, v8, v9
    v_cvt_pk_bf16_f32 v249, v10, v11
    v_cvt_pk_bf16_f32 v250, v12, v13
    v_cvt_pk_bf16_f32 v251, v14, v15
    buffer_store_dwordx4 v[248:251], v1, s[20:23], s32 offen offset:256 sc0 sc1
    v_lshlrev_b32 v16, 16, v252
    v_and_b32 v17, s34, v252
    v_lshlrev_b32 v18, 16, v253
    v_and_b32 v19, s34, v253
    v_lshlrev_b32 v20, 16, v254
    v_and_b32 v21, s34, v254
    v_lshlrev_b32 v22, 16, v255
    v_and_b32 v23, s34, v255
    v_pk_mul_f32 v[16:17], v[16:17], v[40:41]
    v_pk_mul_f32 v[18:19], v[18:19], v[42:43]
    v_pk_mul_f32 v[20:21], v[20:21], v[44:45]
    v_pk_mul_f32 v[22:23], v[22:23], v[46:47]
    v_cvt_pk_bf16_f32 v252, v16, v17
    v_cvt_pk_bf16_f32 v253, v18, v19
    v_cvt_pk_bf16_f32 v254, v20, v21
    v_cvt_pk_bf16_f32 v255, v22, v23
    buffer_store_dwordx4 v[252:255], v1, s[20:23], s32 offen offset:512 sc0 sc1
    s_waitcnt lgkmcnt(0)
    s_add_u32 s32, s33, 0
    v_lshlrev_b32 v8, 16, v64
    v_and_b32 v9, s34, v64
    v_lshlrev_b32 v10, 16, v65
    v_and_b32 v11, s34, v65
    v_lshlrev_b32 v12, 16, v66
    v_and_b32 v13, s34, v66
    v_lshlrev_b32 v14, 16, v67
    v_and_b32 v15, s34, v67
    v_pk_mul_f32 v[8:9], v[8:9], v[24:25]
    v_pk_mul_f32 v[10:11], v[10:11], v[26:27]
    v_pk_mul_f32 v[12:13], v[12:13], v[28:29]
    v_pk_mul_f32 v[14:15], v[14:15], v[30:31]
    v_cvt_pk_bf16_f32 v64, v8, v9
    v_cvt_pk_bf16_f32 v65, v10, v11
    v_cvt_pk_bf16_f32 v66, v12, v13
    v_cvt_pk_bf16_f32 v67, v14, v15
    buffer_store_dwordx4 v[64:67], v1, s[20:23], s32 offen offset:0 sc0 sc1
    v_lshlrev_b32 v16, 16, v68
    v_and_b32 v17, s34, v68
    v_lshlrev_b32 v18, 16, v69
    v_and_b32 v19, s34, v69
    v_lshlrev_b32 v20, 16, v70
    v_and_b32 v21, s34, v70
    v_lshlrev_b32 v22, 16, v71
    v_and_b32 v23, s34, v71
    v_pk_mul_f32 v[16:17], v[16:17], v[32:33]
    v_pk_mul_f32 v[18:19], v[18:19], v[34:35]
    v_pk_mul_f32 v[20:21], v[20:21], v[36:37]
    v_pk_mul_f32 v[22:23], v[22:23], v[38:39]
    v_cvt_pk_bf16_f32 v68, v16, v17
    v_cvt_pk_bf16_f32 v69, v18, v19
    v_cvt_pk_bf16_f32 v70, v20, v21
    v_cvt_pk_bf16_f32 v71, v22, v23
    buffer_store_dwordx4 v[68:71], v1, s[20:23], s32 offen offset:256 sc0 sc1
    v_lshlrev_b32 v8, 16, v72
    v_and_b32 v9, s34, v72
    v_lshlrev_b32 v10, 16, v73
    v_and_b32 v11, s34, v73
    v_lshlrev_b32 v12, 16, v74
    v_and_b32 v13, s34, v74
    v_lshlrev_b32 v14, 16, v75
    v_and_b32 v15, s34, v75
    v_pk_mul_f32 v[8:9], v[8:9], v[40:41]
    v_pk_mul_f32 v[10:11], v[10:11], v[42:43]
    v_pk_mul_f32 v[12:13], v[12:13], v[44:45]
    v_pk_mul_f32 v[14:15], v[14:15], v[46:47]
    v_cvt_pk_bf16_f32 v72, v8, v9
    v_cvt_pk_bf16_f32 v73, v10, v11
    v_cvt_pk_bf16_f32 v74, v12, v13
    v_cvt_pk_bf16_f32 v75, v14, v15
    buffer_store_dwordx4 v[72:75], v1, s[20:23], s32 offen offset:512 sc0 sc1
    s_add_u32 s32, s33, 6291456
    v_lshlrev_b32 v16, 16, v76
    v_and_b32 v17, s34, v76
    v_lshlrev_b32 v18, 16, v77
    v_and_b32 v19, s34, v77
    v_lshlrev_b32 v20, 16, v78
    v_and_b32 v21, s34, v78
    v_lshlrev_b32 v22, 16, v79
    v_and_b32 v23, s34, v79
    v_pk_mul_f32 v[16:17], v[16:17], v[24:25]
    v_pk_mul_f32 v[18:19], v[18:19], v[26:27]
    v_pk_mul_f32 v[20:21], v[20:21], v[28:29]
    v_pk_mul_f32 v[22:23], v[22:23], v[30:31]
    v_cvt_pk_bf16_f32 v76, v16, v17
    v_cvt_pk_bf16_f32 v77, v18, v19
    v_cvt_pk_bf16_f32 v78, v20, v21
    v_cvt_pk_bf16_f32 v79, v22, v23
    buffer_store_dwordx4 v[76:79], v1, s[20:23], s32 offen offset:0 sc0 sc1
    v_lshlrev_b32 v8, 16, v80
    v_and_b32 v9, s34, v80
    v_lshlrev_b32 v10, 16, v81
    v_and_b32 v11, s34, v81
    v_lshlrev_b32 v12, 16, v82
    v_and_b32 v13, s34, v82
    v_lshlrev_b32 v14, 16, v83
    v_and_b32 v15, s34, v83
    v_pk_mul_f32 v[8:9], v[8:9], v[32:33]
    v_pk_mul_f32 v[10:11], v[10:11], v[34:35]
    v_pk_mul_f32 v[12:13], v[12:13], v[36:37]
    v_pk_mul_f32 v[14:15], v[14:15], v[38:39]
    v_cvt_pk_bf16_f32 v80, v8, v9
    v_cvt_pk_bf16_f32 v81, v10, v11
    v_cvt_pk_bf16_f32 v82, v12, v13
    v_cvt_pk_bf16_f32 v83, v14, v15
    buffer_store_dwordx4 v[80:83], v1, s[20:23], s32 offen offset:256 sc0 sc1
    v_lshlrev_b32 v16, 16, v84
    v_and_b32 v17, s34, v84
    v_lshlrev_b32 v18, 16, v85
    v_and_b32 v19, s34, v85
    v_lshlrev_b32 v20, 16, v86
    v_and_b32 v21, s34, v86
    v_lshlrev_b32 v22, 16, v87
    v_and_b32 v23, s34, v87
    v_pk_mul_f32 v[16:17], v[16:17], v[40:41]
    v_pk_mul_f32 v[18:19], v[18:19], v[42:43]
    v_pk_mul_f32 v[20:21], v[20:21], v[44:45]
    v_pk_mul_f32 v[22:23], v[22:23], v[46:47]
    v_cvt_pk_bf16_f32 v84, v16, v17
    v_cvt_pk_bf16_f32 v85, v18, v19
    v_cvt_pk_bf16_f32 v86, v20, v21
    v_cvt_pk_bf16_f32 v87, v22, v23
    buffer_store_dwordx4 v[84:87], v1, s[20:23], s32 offen offset:512 sc0 sc1
L_st_done:
L_end:
    s_endpgm
L_noflag:
    s_cmp_lg_u32 s3, 0
    s_cbranch_scc1 L_pubdone
    s_branch L_fallback
L_others:
    s_cmp_lg_u32 s3, 5
    s_cbranch_scc1 L_wait_g
    s_getpc_b64 s[74:75]
L_pc:
    s_sub_u32 s74, s74, L_pc-L_wait_g
    s_subb_u32 s75, s75, 0
    v_lshlrev_b32 v8, 3, v3
    v_min_u32 v8, L_end-L_wait_g, v8
    global_load_dword v63, v8, s[74:75]
    s_mov_b64 s[72:73], 0
    s_mov_b64 exec, 0
    s_branch L_mlp
L_fallback:
    s_waitcnt vmcnt(0) lgkmcnt(0)
    v_bfe_u32 v4, v3, 4, 4
    v_and_b32 v16, 1, v4
    v_cmp_eq_u32 vcc, 1, v16
    v_mov_b32 v17, 0x3f80
    v_mov_b32 v18, 0x3f800000
    v_cndmask_b32 v17, v17, v18, vcc
    v_lshrrev_b32 v16, 1, v4
    v_cmp_eq_u32 vcc, 0, v16
    s_nop 1
    v_cndmask_b32 v8, 0, v17, vcc
    v_cmp_eq_u32 vcc, 1, v16
    s_nop 1
    v_cndmask_b32 v9, 0, v17, vcc
    v_cmp_eq_u32 vcc, 2, v16
    s_nop 1
    v_cndmask_b32 v10, 0, v17, vcc
    v_cmp_eq_u32 vcc, 3, v16
    s_nop 1
    v_cndmask_b32 v11, 0, v17, vcc
    v_cmp_eq_u32 vcc, 4, v16
    s_nop 1
    v_cndmask_b32 v12, 0, v17, vcc
    v_cmp_eq_u32 vcc, 5, v16
    s_nop 1
    v_cndmask_b32 v13, 0, v17, vcc
    v_cmp_eq_u32 vcc, 6, v16
    s_nop 1
    v_cndmask_b32 v14, 0, v17, vcc
    v_cmp_eq_u32 vcc, 7, v16
    s_nop 1
    v_cndmask_b32 v15, 0, v17, vcc
    v_mov_b32 v16, 0
    v_mov_b32 v17, 0
    v_mov_b32 v18, 0
    v_mov_b32 v19, 0
    v_mov_b32 v20, 0
    v_mov_b32 v21, 0
    v_mov_b32 v22, 0
    v_mov_b32 v23, 0
    v_mov_b32 v24, 0
    v_mov_b32 v25, 0
    v_mov_b32 v26, 0
    v_mov_b32 v27, 0
    v_mov_b32 v28, 0x3e000000
    v_lshrrev_b32 v60, 1, v5
    v_lshlrev_b32 v60, 5, v60
    v_lshl_add_u32 v60, v4, 1, v60
    v_and_b32 v61, 1, v5
    v_add_u32 v60, v60, v61
    v_mul_u32_u24 v61, 43, v60
    v_lshrrev_b32 v61, 7, v61
    v_add_u32 v61, v60, v61
    v_lshlrev_b32 v63, 2, v60
    v_subrev_u32 v63, 189, v63
    v_cmp_gt_u32 vcc, 48, v60
    s_nop 1
    v_cndmask_b32 v60, v63, v61, vcc
    v_lshlrev_b32 v60, 4, v60
    s_mov_b32 s36, 0
L_fb_loop:
    buffer_load_dwordx4 v[48:51], v1, s[16:19], s36 offen offset:0
    buffer_load_dwordx4 v[52:55], v1, s[16:19], s36 offen offset:256
    buffer_load_dwordx4 v[56:59], v1, s[16:19], s36 offen offset:512
    s_waitcnt vmcnt(0)
    v_mfma_f32_16x16x32_bf16 v[16:19], v[8:11], v[48:51], v[16:19]
    v_mfma_f32_16x16x32_bf16 v[16:19], v[12:15], v[52:55], v[16:19]
    v_mfma_f32_16x16x32_bf16 v[24:27], v[8:11], v[52:55], v[24:27]
    v_mfma_f32_16x16x32_bf16 v[24:27], v[12:15], v[56:59], v[24:27]
    v_mfma_f32_16x16x32_bf16 v[20:23], v[8:11], v[56:59], v[20:23]
    s_add_u32 s36, s36, 3072
    s_cmp_lt_u32 s36, 100663296
    s_cbranch_scc1 L_fb_loop
    s_nop 7
    v_add_f32_dpp v16, v24, v16 row_ror:8 row_mask:0xf bank_mask:0x3
    v_add_f32_dpp v17, v25, v17 row_ror:8 row_mask:0xf bank_mask:0x3
    v_add_f32_dpp v18, v26, v18 row_ror:8 row_mask:0xf bank_mask:0x3
    v_add_f32_dpp v19, v27, v19 row_ror:8 row_mask:0xf bank_mask:0x3
    v_add_f32_dpp v16, v20, v16 row_ror:8 row_mask:0x3 bank_mask:0xc
    v_add_f32_dpp v17, v21, v17 row_ror:8 row_mask:0x3 bank_mask:0xc
    v_add_f32_dpp v18, v22, v18 row_ror:8 row_mask:0x3 bank_mask:0xc
    v_add_f32_dpp v19, v23, v19 row_ror:8 row_mask:0x3 bank_mask:0xc
    v_mov_b32_dpp v16, v28 quad_perm:[0,1,2,3] row_mask:0xc bank_mask:0xc
    ds_write_b128 v60, v[16:19] offset:0
    v_mul_u32_u24 v63, 192, v5
    v_lshrrev_b32 v59, 2, v4
    v_mad_u32_u24 v63, v59, 24, v63
    v_and_b32 v59, 3, v4
    v_lshl_add_u32 v63, v59, 3, v63
    ds_read_b64_tr_b16 v[24:25], v63 offset:12288
    ds_read_b64_tr_b16 v[26:27], v63 offset:12384
    ds_read_b64_tr_b16 v[28:29], v63 offset:13056
    ds_read_b64_tr_b16 v[30:31], v63 offset:13152
    ds_read_b64_tr_b16 v[32:33], v63 offset:13824
    ds_read_b64_tr_b16 v[34:35], v63 offset:13920
    ds_read_b64_tr_b16 v[36:37], v63 offset:14592
    ds_read_b64_tr_b16 v[38:39], v63 offset:14688
    ds_read_b64_tr_b16 v[40:41], v63 offset:15360
    ds_read_b64_tr_b16 v[42:43], v63 offset:15456
    ds_read_b64_tr_b16 v[44:45], v63 offset:16128
    ds_read_b64_tr_b16 v[46:47], v63 offset:16224
    ds_read_b128 v[8:11], v3 offset:0
    v_lshrrev_b32 v60, 1, v3
    v_lshrrev_b32 v61, 6, v3
    v_lshlrev_b32 v61, 3, v61
    v_sub_u32 v60, v60, v61
    v_lshlrev_b32 v61, 4, v5
    s_waitcnt lgkmcnt(0)
    s_mov_b32 exec_lo, 0x77777777
    s_mov_b32 exec_hi, 0x77777777
    s_branch L_mlp
.section .rodata,"a"
.p2align 6
.amdhsa_kernel standalone__channel_attn_se__vision_kernel
  .amdhsa_next_free_vgpr 256
  .amdhsa_next_free_sgpr 80
  .amdhsa_accum_offset 256
  .amdhsa_group_segment_fixed_size 0
  .amdhsa_kernarg_size 48
  .amdhsa_user_sgpr_count 2
  .amdhsa_user_sgpr_kernarg_segment_ptr 1
  .amdhsa_system_sgpr_workgroup_id_x 1
  .amdhsa_float_denorm_mode_32 3
  .amdhsa_float_denorm_mode_16_64 3
.end_amdhsa_kernel
```
